```python
import torch

def _softmax(x, axis=-1):
    return torch.softmax(x, dim=axis)
def _gelu(x):
    return torch.nn.functional.gelu(x, approximate="tanh")
def _silu(x):
    return torch.nn.functional.silu(x)
def _sigmoid(x):
    return torch.sigmoid(x)
def _layernorm(x, axis=-1, eps=1e-5):
    m = x.mean(dim=axis, keepdim=True)
    v = x.var(dim=axis, keepdim=True, unbiased=False)
    return (x - m) / torch.sqrt(v + eps)
def _scatter_add(tgt, idx, src, axis=0):
    return tgt.clone().index_add_(axis, idx, src)
def _segment_sum(src, seg, n):
    out = torch.zeros((n,) + src.shape[1:], dtype=src.dtype)
    return out.index_add_(0, seg, src)
def _pad(x, pw):
    flat = tuple(v for pair in reversed(pw) for v in pair)
    return torch.nn.functional.pad(x, flat)

kernel_name = 'parallel_sum__ssm_conv_s5__dense_activation_silu__prompt'

def setup_inputs():

    _w = (lambda a: (lambda t: t.to(torch.bfloat16) if t.is_floating_point() else t)(torch.as_tensor(a)))
    def _A_setup():
        B, S, D = 1, 2048, 512
        P = D
        Lambda_re = -0.5 * (lambda _x: torch.exp(torch.as_tensor(_x)))((lambda *s: torch.randn(*s, dtype=torch.bfloat16) * 0.2)(P))
        Lambda_im = (lambda *s: torch.randn(*s, dtype=torch.bfloat16) * 0.8)(P) * 1.0
        B_re = (lambda *s: torch.randn(*s, dtype=torch.bfloat16) * 0.2)(P, D) * (D ** -0.5)
        B_im = (lambda *s: torch.randn(*s, dtype=torch.bfloat16) * 0.2)(P, D) * (D ** -0.5)
        C_re = (lambda *s: torch.randn(*s, dtype=torch.bfloat16) * 0.2)(D, P) * (P ** -0.5)
        C_im = (lambda *s: torch.randn(*s, dtype=torch.bfloat16) * 0.2)(D, P) * (P ** -0.5)
        log_dt = (lambda *s: torch.randn(*s, dtype=torch.bfloat16) * 0.2)(P) * 0.3 - 2.0
        Dskip = (lambda *s: torch.randn(*s, dtype=torch.bfloat16) * 0.05)(D)
        return {
            "x": _w((lambda *s: torch.randn(*s, dtype=torch.bfloat16) * 0.05)(B, S, D)),
            "Lambda_re": _w(Lambda_re),
            "Lambda_im": _w(Lambda_im),
            "B_re": _w(B_re),
            "B_im": _w(B_im),
            "C_re": _w(C_re),
            "C_im": _w(C_im),
            "log_dt": _w(log_dt),
            "Dskip": _w(Dskip),
        }
    _A_in = _A_setup()

    def _B_setup():
        B, S, D, F = 1, 2048, 512, 1376
        return {
            "x": _w((lambda *s: torch.randn(*s, dtype=torch.bfloat16) * 0.05)(B, S, D)),
            "w1": _w((lambda *s: torch.randn(*s, dtype=torch.bfloat16) * 0.8)(D, F) * (D ** -0.5)),
            "w2": _w((lambda *s: torch.randn(*s, dtype=torch.bfloat16) * 0.2)(F, D) * (F ** -0.5)),
        }
    _B_in = _B_setup()

    return {
        "A_x": _A_in["x"],
        "A_Lambda_re": _A_in["Lambda_re"],
        "A_Lambda_im": _A_in["Lambda_im"],
        "A_B_re": _A_in["B_re"],
        "A_B_im": _A_in["B_im"],
        "A_C_re": _A_in["C_re"],
        "A_C_im": _A_in["C_im"],
        "A_log_dt": _A_in["log_dt"],
        "A_Dskip": _A_in["Dskip"],
        "B_x": _B_in["x"],
        "B_w1": _B_in["w1"],
        "B_w2": _B_in["w2"],
    }

def reference(A_x, A_Lambda_re, A_Lambda_im, A_B_re, A_B_im, A_C_re, A_C_im, A_log_dt, A_Dskip, B_x, B_w1, B_w2):
    def _A_ref(x, Lambda_re, Lambda_im, B_re, B_im, C_re, C_im, log_dt, Dskip):
        Bsz, L, H = x.shape
        Lam = Lambda_re + 1j * Lambda_im
        Bmat = B_re + 1j * B_im
        Cmat = C_re + 1j * C_im
        dt = torch.exp(log_dt)
        Lam_bar = torch.exp(dt * Lam)
        B_bar = ((Lam_bar - 1.0) / Lam)[:, None] * Bmat
        Bu = torch.einsum("bld,pd->blp", x + 0j, B_bar)
        h = torch.zeros_like(Bu[:, 0, :])
        hs = []
        for t in range(L):
            h = Lam_bar[None, :] * h + Bu[:, t, :]
            hs.append(h)
        hseq = torch.stack(hs, 1)
        y = 2.0 * torch.einsum("blp,dp->bld", hseq, Cmat).real + x * Dskip[None, None, :]
        return y

    def _B_ref(x, w1, w2):
        h = torch.einsum("bsd,df->bsf", x, w1)
        h = _silu(h)
        out = torch.einsum("bsf,fd->bsd", h, w2)
        return out

    x = A_x
    xn = _layernorm(x, axis=-1)
    return x + _A_ref(xn, A_Lambda_re, A_Lambda_im, A_B_re, A_B_im, A_C_re, A_C_im, A_log_dt, A_Dskip) + _B_ref(xn, B_w1, B_w2)
```

```asm
; @launch grid=(256,1,1) block=(512,1,1) lds=163840
.amdgcn_target "amdgcn-amd-amdhsa--gfx950"
.text
.globl parallel_sum__ssm_conv_s5__dense_activation_silu__prompt_kernel
.p2align 8
.type parallel_sum__ssm_conv_s5__dense_activation_silu__prompt_kernel,@function
parallel_sum__ssm_conv_s5__dense_activation_silu__prompt_kernel:
    s_load_dwordx16 s[16:31], s[0:1], 0
    s_load_dwordx16 s[32:47], s[0:1], 56
    s_cmpk_ge_u32 s2, 256
    s_cbranch_scc1 L_END
    v_readfirstlane_b32 s3, v0
    v_and_b32 v0, 63, v0
    s_lshr_b32 s8, s2, 5
    s_and_b32 s13, s2, 6
    s_lshl_b32 s13, s13, 1
    s_lshr_b32 s13, 9766, s13
    s_and_b32 s13, s13, 6
    s_xor_b32 s2, s2, s13
    s_and_b32 s14, s2, 6
    s_lshl_b32 s5, s14, 1
    s_lshr_b32 s13, s2, 3
    s_and_b32 s13, s13, 3
    s_or_b32 s5, s5, s13
    s_and_b32 s15, s2, 1
    s_lshl3_add_u32 s6, s15, s8
    s_lshr_b32 s3, s3, 6
    s_and_b32 s4, s3, 3
    s_cmp_ge_u32 s3, 4
    s_cbranch_scc1 L_FWAVE
    v_lshlrev_b32 v32, 4, v0
    s_lshl4_add_u32 s11, s5, s6
    s_lshl2_add_u32 s11, s11, s4
    v_lshl_add_u32 v33, s11, 11, v32
    s_lshl2_add_u32 s12, s5, s4
    s_and_b32 s78, s12, 31
    s_lshl_b32 s79, s6, 5
    s_add_u32 s78, s78, s79
    v_lshl_add_u32 v34, s78, 10, v32
    s_cmp_ge_u32 s5, 8
    s_waitcnt lgkmcnt(0)
    global_load_dwordx4 v[48:51], v33, s[16:17]
    global_load_dwordx4 v[52:55], v33, s[16:17] offset:1024
    s_cselect_b64 s[52:53], s[24:25], s[22:23]
    global_load_dwordx4 v[56:59], v34, s[52:53]
    s_cmp_lg_u32 s4, 0
    s_cbranch_scc1 NOPF_35
    s_getpc_b64 s[56:57]
L_PC:
    s_sub_u32 s56, s56, L_PC-parallel_sum__ssm_conv_s5__dense_activation_silu__prompt_kernel
    s_subb_u32 s57, s57, 0
    s_mov_b32 s58, L_CODE_END-parallel_sum__ssm_conv_s5__dense_activation_silu__prompt_kernel
    s_mov_b32 s59, 0x20000
    s_lshr_b32 s77, s2, 3
    s_lshl_b32 s77, s77, 10
    buffer_load_dwordx4 v[60:63], v32, s[56:59], s77 offen
NOPF_35:
    v_and_b32 v28, 15, v0
    s_and_b32 s77, s4, 1
    s_lshl4_add_u32 s79, s77, s79
    v_add_lshl_u32 v28, v28, s79, 1
    global_load_ushort v29, v28, s[18:19]
    global_load_ushort v30, v28, s[20:21]
    global_load_ushort v31, v28, s[30:31]
    s_mov_b32 s10, 0xa60000
    s_load_dword s10, s[46:47], s10
    s_branch L_SREST
L_FWAVE:
    s_lshl2_add_u32 s9, s15, s14
    v_lshrrev_b32 v33, 3, v0
    v_and_b32 v32, 7, v0
    v_lshrrev_b32 v34, 4, v0
    v_xor_b32 v32, v32, v34
    v_lshlrev_b32 v32, 4, v32
    v_lshl_or_b32 v6, v33, 10, v32
    v_lshrrev_b32 v34, 5, v0
    v_mul_u32_u24 v34, 12288, v34
    v_add_u32 v2, v34, v6
    v_add_u32 v3, 3072, v2
    v_xor_b32 v3, 64, v3
    v_add_u32 v4, 6144, v2
    v_add_u32 v5, 6144, v3
    s_lshl2_add_u32 s73, s5, s4
    s_lshl_b32 s73, s73, 15
    s_lshl_b32 s14, s4, 12
    s_mov_b32 s50, 0x200000
    s_mov_b32 s51, 0x20000
    s_add_u32 s77, s9, 0
    s_and_b32 s77, s77, 7
    s_lshl_b32 s77, s77, 7
    s_add_u32 m0, s14, 0
    s_add_u32 s78, s77, s73
    s_waitcnt lgkmcnt(0)
    s_mov_b64 s[48:49], s[16:17]
    buffer_load_dwordx4 v2, s[48:51], s78 offen offset:0 lds
    v_add_u32 v7, 15360, v6
    v_xor_b32 v7, 64, v7
    s_and_b32 s11, s4, 1
    buffer_load_dwordx4 v3, s[48:51], s78 offen offset:1024 lds
    s_lshl2_add_u32 s74, s6, s11
    s_lshl_b32 s74, s74, 13
    s_lshl_b32 s15, s4, 11
    buffer_load_dwordx4 v4, s[48:51], s78 offen offset:2048 lds
    s_add_u32 s15, s15, 16384
    s_mov_b32 s54, 0x80000
    s_mov_b32 s55, 0x20000
    buffer_load_dwordx4 v5, s[48:51], s78 offen offset:3072 lds
    s_cmp_ge_u32 s4, 2
    s_cselect_b64 s[52:53], s[24:25], s[22:23]
    s_add_u32 m0, s15, 0
    s_add_u32 s78, s77, s74
    buffer_load_dwordx4 v6, s[52:55], s78 offen offset:0 lds
    buffer_load_dwordx4 v7, s[52:55], s78 offen offset:1024 lds
    s_add_u32 s77, s9, 1
    s_and_b32 s77, s77, 7
    s_lshl_b32 s77, s77, 7
    s_add_u32 m0, s14, 24576
    s_add_u32 s78, s77, s73
    buffer_load_dwordx4 v2, s[48:51], s78 offen offset:0 lds
    s_mov_b32 s10, 0xa60000
    s_load_dword s10, s[46:47], s10
    s_and_b32 s7, s2, 7
    s_lshr_b32 s32, s2, 3
    s_and_b32 s32, s32, 3
    buffer_load_dwordx4 v3, s[48:51], s78 offen offset:1024 lds
    s_lshl2_add_u32 s7, s7, s32
    v_and_b32 v12, 15, v0
    v_lshrrev_b32 v32, 1, v12
    v_lshrrev_b32 v33, 4, v0
    v_xor_b32 v32, v32, v33
    buffer_load_dwordx4 v4, s[48:51], s78 offen offset:2048 lds
    v_lshl_add_u32 v32, v32, 4, s14
    v_lshl_add_u32 v12, v12, 7, v32
    s_and_b32 s32, s4, 1
    s_lshl_b32 s32, s32, 6
    v_xor_b32 v12, s32, v12
    buffer_load_dwordx4 v5, s[48:51], s78 offen offset:3072 lds
    v_xor_b32 v13, 64, v12
    s_mov_b32 s56, s38
    s_mov_b32 s57, s39
    s_mov_b32 s58, 0x158000
    s_mov_b32 s59, 0x20000
    s_add_u32 m0, s15, 24576
    s_add_u32 s78, s77, s74
    buffer_load_dwordx4 v6, s[52:55], s78 offen offset:0 lds
    s_mov_b32 s32, 683
    s_add_u32 s33, s6, 1
    s_xor_b32 s33, s33, s6
    s_and_b32 s33, s33, 4
    s_lshl_b32 s33, s33, 1
    buffer_load_dwordx4 v7, s[52:55], s78 offen offset:1024 lds
    s_cmp_eq_u32 s6, 15
    s_cselect_b32 s33, 12, s33
    v_add_u32 v32, 0, v0
    v_mul_u32_u24 v33, s32, v32
    v_lshrrev_b32 v33, 13, v33
    s_add_u32 s77, s9, 2
    s_and_b32 s77, s77, 7
    s_lshl_b32 s77, s77, 7
    s_add_u32 m0, s14, 49152
    s_add_u32 s78, s77, s73
    buffer_load_dwordx4 v2, s[48:51], s78 offen offset:0 lds
    v_mul_u32_u24 v34, 12, v33
    v_sub_u32 v34, v32, v34
    v_lshrrev_b32 v32, 2, v33
    v_and_b32 v32, 2, v32
    v_xor_b32 v34, v34, v32
    buffer_load_dwordx4 v3, s[48:51], s78 offen offset:1024 lds
    v_mul_u32_u24 v33, 2752, v33
    v_lshl_add_u32 v8, v34, 4, v33
    v_and_b32 v34, s33, v34
    v_lshl_add_u32 v8, v34, 26, v8
    v_add_u32 v32, 64, v0
    buffer_load_dwordx4 v4, s[48:51], s78 offen offset:2048 lds
    v_mul_u32_u24 v33, s32, v32
    v_lshrrev_b32 v33, 13, v33
    v_mul_u32_u24 v34, 12, v33
    v_sub_u32 v34, v32, v34
    v_lshrrev_b32 v32, 2, v33
    buffer_load_dwordx4 v5, s[48:51], s78 offen offset:3072 lds
    v_and_b32 v32, 2, v32
    v_xor_b32 v34, v34, v32
    v_mul_u32_u24 v33, 2752, v33
    v_lshl_add_u32 v9, v34, 4, v33
    v_subrev_u32 v9, 1024, v9
    s_add_u32 m0, s15, 49152
    s_add_u32 s78, s77, s74
    buffer_load_dwordx4 v6, s[52:55], s78 offen offset:0 lds
    v_and_b32 v34, s33, v34
    v_lshl_add_u32 v9, v34, 26, v9
    v_add_u32 v32, 128, v0
    v_mul_u32_u24 v33, s32, v32
    v_lshrrev_b32 v33, 13, v33
    buffer_load_dwordx4 v7, s[52:55], s78 offen offset:1024 lds
    v_mul_u32_u24 v34, 12, v33
    v_sub_u32 v34, v32, v34
    v_lshrrev_b32 v32, 2, v33
    v_and_b32 v32, 2, v32
    v_xor_b32 v34, v34, v32
    s_add_u32 s77, s9, 3
    s_and_b32 s77, s77, 7
    s_lshl_b32 s77, s77, 7
    s_add_u32 m0, s14, 73728
    s_add_u32 s78, s77, s73
    s_waitcnt vmcnt(12) lgkmcnt(0)
    s_barrier
    s_mul_i32 s10, s10, 0x9E3779B1
    s_add_u32 s10, s10, 0x7F4A7C15
    buffer_load_dwordx4 v2, s[48:51], s78 offen offset:0 lds
    v_mul_u32_u24 v33, 2752, v33
    v_lshl_add_u32 v10, v34, 4, v33
    v_subrev_u32 v10, 2048, v10
    v_and_b32 v34, s33, v34
    v_lshl_add_u32 v10, v34, 26, v10
    buffer_load_dwordx4 v3, s[48:51], s78 offen offset:1024 lds
    s_lshr_b32 s32, s6, 2
    s_mul_i32 s12, s32, 11
    s_and_b32 s32, s6, 3
    s_mul_i32 s32, s32, 3
    s_add_u32 s12, s12, s32
    buffer_load_dwordx4 v4, s[48:51], s78 offen offset:2048 lds
    s_lshl_b32 s75, s12, 6
    s_mul_i32 s32, s4, 44032
    s_add_u32 s75, s75, s32
    s_mul_i32 s13, s4, 3072
    s_mov_b32 s60, s40
    buffer_load_dwordx4 v5, s[48:51], s78 offen offset:3072 lds
    s_mov_b32 s61, s41
    s_mov_b32 s62, 0x158000
    s_mov_b32 s63, 0x20000
    s_mov_b32 s64, s46
    s_mov_b32 s65, s47
    s_add_u32 m0, s15, 73728
    s_add_u32 s78, s77, s74
    buffer_load_dwordx4 v6, s[52:55], s78 offen offset:0 lds
    s_mov_b32 s66, 0xc00000
    s_mov_b32 s67, 0x20000
    s_mov_b32 s68, s42
    s_mov_b32 s69, s43
    s_mov_b32 s70, 0x400000
    buffer_load_dwordx4 v7, s[52:55], s78 offen offset:1024 lds
    s_mov_b32 s71, 0x20000
    v_lshrrev_b32 v32, 4, v0
    v_bfe_u32 v33, v0, 2, 2
    v_lshl_add_u32 v32, v32, 3, v33
    v_mul_u32_u24 v32, 192, v32
    ds_read_b128 v[128:131], v12 offset:0
    ds_read_b128 v[132:135], v12 offset:2048
    ds_read_b128 v[136:139], v13 offset:0
    ds_read_b128 v[140:143], v13 offset:2048
    s_add_u32 s77, s9, 4
    s_and_b32 s77, s77, 7
    s_lshl_b32 s77, s77, 7
    s_add_u32 m0, s14, 98304
    s_add_u32 s78, s77, s73
    s_waitcnt vmcnt(12) lgkmcnt(4)
    s_barrier
    buffer_load_dwordx4 v2, s[48:51], s78 offen offset:0 lds
    v_bfe_u32 v33, v0, 4, 1
    s_lshr_b32 s32, s4, 1
    v_xor_b32 v33, s32, v33
    v_lshl_add_u32 v32, v33, 5, v32
    v_and_b32 v33, 3, v0
    buffer_load_dwordx4 v3, s[48:51], s78 offen offset:1024 lds
    v_lshl_add_u32 v32, v33, 3, v32
    v_mov_b32 v22, 0
    v_bfe_u32 v33, v0, 2, 2
    v_lshrrev_b32 v34, 4, v0
    v_cmp_eq_u32 vcc, v33, v34
    buffer_load_dwordx4 v4, s[48:51], s78 offen offset:2048 lds
    v_mov_b32 v33, 0x3f803f80
    s_nop 0
    v_cndmask_b32 v28, 0, v33, vcc
    v_cndmask_b32 v29, 0, v33, vcc
    v_cndmask_b32 v30, 0, v33, vcc
    buffer_load_dwordx4 v5, s[48:51], s78 offen offset:3072 lds
    v_cndmask_b32 v31, 0, v33, vcc
    s_and_b32 s32, s4, 1
    s_mul_i32 s32, s32, 6144
    s_add_u32 s33, s32, 49152
    v_add_u32 v16, s33, v32
    s_add_u32 m0, s15, 98304
    s_add_u32 s78, s77, s74
    buffer_load_dwordx4 v6, s[52:55], s78 offen offset:0 lds
    s_sub_u32 s33, 55296, s32
    v_add_u32 v18, s33, v32
    v_xor_b32 v17, 32, v16
    v_xor_b32 v19, 32, v18
    v_lshlrev_b32 v20, 2, v0
    buffer_load_dwordx4 v7, s[52:55], s78 offen offset:1024 lds
    v_add_u32 v20, 154624, v20
    v_mov_b32 v21, 148992
    v_cmp_eq_u32 vcc, 0, v0
    s_nop 1
    v_cndmask_b32 v20, v20, v21, vcc
    ds_read_b128 v[144:147], v12 offset:24576
    ds_read_b128 v[148:151], v12 offset:26624
    ds_read_b128 v[152:155], v13 offset:24576
    ds_read_b128 v[156:159], v13 offset:26624
    s_add_u32 s77, s9, 5
    s_and_b32 s77, s77, 7
    s_lshl_b32 s77, s77, 7
    s_add_u32 m0, s14, 122880
    s_add_u32 s78, s77, s73
    s_waitcnt vmcnt(12) lgkmcnt(4)
    s_barrier
    buffer_load_dwordx4 v2, s[48:51], s78 offen offset:0 lds
    v_mov_b32 v21, 1
    v_and_b32 v26, 15, v0
    s_lshl_b32 s32, s4, 7
    s_add_u32 s32, s32, 147968
    v_lshl_add_u32 v26, v26, 2, s32
    buffer_load_dwordx4 v3, s[48:51], s78 offen offset:1024 lds
    v_lshlrev_b32 v11, 4, v0
    v_add_u32 v25, 151552, v11
    s_lshl_b32 s32, s4, 2
    v_add_u32 v1, s32, v25
    v_lshrrev_b32 v32, 3, v0
    buffer_load_dwordx4 v4, s[48:51], s78 offen offset:2048 lds
    v_and_b32 v33, 7, v0
    v_lshrrev_b32 v34, 4, v0
    v_lshlrev_b32 v34, 1, v34
    v_xor_b32 v33, v33, v34
    v_lshlrev_b32 v33, 4, v33
    buffer_load_dwordx4 v5, s[48:51], s78 offen offset:3072 lds
    v_lshl_or_b32 v14, v32, 10, v33
    v_add_u32 v15, 7168, v14
    v_add_u32 v23, 14336, v14
    v_add_u32 v24, 21504, v14
    v_lshrrev_b32 v32, 4, v0
    s_add_u32 m0, s15, 122880
    s_add_u32 s78, s77, s74
    buffer_load_dwordx4 v6, s[52:55], s78 offen offset:0 lds
    v_and_b32 v27, 15, v0
    v_lshlrev_b32 v27, 4, v27
    v_lshl_or_b32 v27, v32, 9, v27
    s_mul_i32 s82, s4, 6144
    s_mul_i32 s83, s4, 49152
    buffer_load_dwordx4 v7, s[52:55], s78 offen offset:1024 lds
    s_lshl_b32 s32, s8, 7
    s_add_u32 s83, s83, s32
    s_lshl2_add_u32 s32, s5, s4
    s_mul_i32 s32, s32, 163840
    s_mul_i32 s33, s6, 6144
    ds_read_b128 v[160:163], v12 offset:49152
    ds_read_b128 v[164:167], v12 offset:51200
    ds_read_b128 v[168:171], v13 offset:49152
    ds_read_b128 v[172:175], v13 offset:51200
    s_add_u32 s77, s9, 6
    s_and_b32 s77, s77, 7
    s_lshl_b32 s77, s77, 7
    s_add_u32 m0, s14, 0
    s_add_u32 s78, s77, s73
    s_waitcnt vmcnt(12) lgkmcnt(4)
    s_barrier
    buffer_load_dwordx4 v2, s[48:51], s78 offen offset:0 lds
    s_add_u32 s32, s32, s33
    s_add_u32 s79, s32, 65536
    s_bfe_i32 s33, s4, 0x10001
    s_mov_b32 s84, 0x07060302
    buffer_load_dwordx4 v3, s[48:51], s78 offen offset:1024 lds
    buffer_load_dwordx4 v4, s[48:51], s78 offen offset:2048 lds
    buffer_load_dwordx4 v5, s[48:51], s78 offen offset:3072 lds
    s_add_u32 m0, s15, 0
    s_add_u32 s78, s77, s74
    buffer_load_dwordx4 v6, s[52:55], s78 offen offset:0 lds
    buffer_load_dwordx4 v7, s[52:55], s78 offen offset:1024 lds
    v_add_u32 v12, 73728, v12
    v_add_u32 v13, 73728, v13
    ds_read_b128 v[176:179], v12 offset:0
    ds_read_b128 v[180:183], v12 offset:2048
    ds_read_b128 v[184:187], v13 offset:0
    ds_read_b128 v[188:191], v13 offset:2048
    s_add_u32 s77, s9, 7
    s_and_b32 s77, s77, 7
    s_lshl_b32 s77, s77, 7
    s_add_u32 m0, s14, 24576
    s_add_u32 s78, s77, s73
    s_waitcnt vmcnt(12) lgkmcnt(4)
    s_barrier
    buffer_load_dwordx4 v2, s[48:51], s78 offen offset:0 lds
    buffer_load_dwordx4 v3, s[48:51], s78 offen offset:1024 lds
    buffer_load_dwordx4 v4, s[48:51], s78 offen offset:2048 lds
    buffer_load_dwordx4 v5, s[48:51], s78 offen offset:3072 lds
    s_add_u32 m0, s15, 24576
    s_add_u32 s78, s77, s74
    buffer_load_dwordx4 v6, s[52:55], s78 offen offset:0 lds
    buffer_load_dwordx4 v7, s[52:55], s78 offen offset:1024 lds
    ds_read_b128 v[192:195], v12 offset:24576
    ds_read_b128 v[196:199], v12 offset:26624
    ds_read_b128 v[200:203], v13 offset:24576
    ds_read_b128 v[204:207], v13 offset:26624
    s_add_u32 s77, s9, 0
    s_and_b32 s77, s77, 7
    s_mul_i32 s77, s77, 176128
    s_add_u32 m0, s13, 49152
    s_add_u32 s78, s77, s75
    s_waitcnt vmcnt(12) lgkmcnt(4)
    s_barrier
    buffer_load_dwordx4 v8, s[56:59], s78 offen offset:0 lds
    buffer_load_dwordx4 v9, s[56:59], s78 offen offset:1024 lds
    buffer_load_dwordx4 v10, s[56:59], s78 offen offset:2048 lds
    s_add_u32 s77, s9, 1
    s_and_b32 s77, s77, 7
    s_mul_i32 s77, s77, 176128
    s_add_u32 m0, s13, 61440
    s_add_u32 s78, s77, s75
    buffer_load_dwordx4 v8, s[56:59], s78 offen offset:0 lds
    buffer_load_dwordx4 v9, s[56:59], s78 offen offset:1024 lds
    buffer_load_dwordx4 v10, s[56:59], s78 offen offset:2048 lds
    ds_read_b128 v[208:211], v12 offset:49152
    ds_read_b128 v[212:215], v12 offset:51200
    ds_read_b128 v[216:219], v13 offset:49152
    ds_read_b128 v[220:223], v13 offset:51200
    s_add_u32 s77, s9, 2
    s_and_b32 s77, s77, 7
    s_mul_i32 s77, s77, 176128
    s_add_u32 m0, s13, 73728
    s_add_u32 s78, s77, s75
    s_waitcnt vmcnt(12) lgkmcnt(4)
    s_barrier
    buffer_load_dwordx4 v8, s[56:59], s78 offen offset:0 lds
    buffer_load_dwordx4 v9, s[56:59], s78 offen offset:1024 lds
    buffer_load_dwordx4 v10, s[56:59], s78 offen offset:2048 lds
    s_add_u32 s77, s9, 3
    s_and_b32 s77, s77, 7
    s_mul_i32 s77, s77, 176128
    s_add_u32 m0, s13, 86016
    s_add_u32 s78, s77, s75
    buffer_load_dwordx4 v8, s[56:59], s78 offen offset:0 lds
    buffer_load_dwordx4 v9, s[56:59], s78 offen offset:1024 lds
    buffer_load_dwordx4 v10, s[56:59], s78 offen offset:2048 lds
    v_subrev_u32 v12, 73728, v12
    v_subrev_u32 v13, 73728, v13
    ds_read_b128 v[224:227], v12 offset:0
    ds_read_b128 v[228:231], v12 offset:2048
    ds_read_b128 v[232:235], v13 offset:0
    ds_read_b128 v[236:239], v13 offset:2048
    s_add_u32 s77, s9, 4
    s_and_b32 s77, s77, 7
    s_mul_i32 s77, s77, 176128
    s_add_u32 m0, s13, 98304
    s_add_u32 s78, s77, s75
    s_waitcnt vmcnt(12) lgkmcnt(4)
    s_barrier
    buffer_load_dwordx4 v8, s[56:59], s78 offen offset:0 lds
    buffer_load_dwordx4 v9, s[56:59], s78 offen offset:1024 lds
    buffer_load_dwordx4 v10, s[56:59], s78 offen offset:2048 lds
    ds_read_b128 v[240:243], v12 offset:24576
    ds_read_b128 v[244:247], v12 offset:26624
    ds_read_b128 v[248:251], v13 offset:24576
    ds_read_b128 v[252:255], v13 offset:26624
    ds_add_u32 v20, v21 offset:0
    s_add_u32 s77, s9, 5
    s_and_b32 s77, s77, 7
    s_mul_i32 s77, s77, 176128
    s_add_u32 m0, s13, 110592
    s_add_u32 s78, s77, s75
    buffer_load_dwordx4 v8, s[56:59], s78 offen offset:0 lds
    buffer_load_dwordx4 v9, s[56:59], s78 offen offset:1024 lds
    buffer_load_dwordx4 v10, s[56:59], s78 offen offset:2048 lds
    s_setprio 1
    s_lshl2_add_u32 s77, s2, s4
    s_lshl_b32 s77, s77, 10
    s_mov_b32 m0, 151552
    s_bitcmp1_b32 s4, 0
    s_cselect_b64 s[52:53], s[28:29], s[26:27]
    s_lshr_b32 s78, s77, 11
    s_lshl_b32 s78, s78, 10
    buffer_load_dwordx4 v11, s[52:55], s78 offen lds
    s_xor_b32 s78, s4, 3
    s_lshl_b32 s78, s78, 8
    s_add_u32 s78, s78, s2
    s_lshl_b32 s78, s78, 10
    s_add_u32 s78, s78, 1048576
    buffer_load_dwordx4 v11, s[60:63], s77 offen lds
    buffer_load_dwordx4 v11, s[60:63], s78 offen lds
    s_waitcnt vmcnt(9)
    ds_add_u32 v20, v21 offset:8
    s_mov_b32 s76, 0x800000
SPIN_1:
    ds_read_b32 v2, v20 offset:8
    s_waitcnt lgkmcnt(0)
    v_readfirstlane_b32 s80, v2
    s_sub_u32 s76, s76, 1
    s_cbranch_scc1 SPR_3
    s_cmp_eq_u32 s80, 4
    s_cbranch_scc1 SPR_3
    s_sleep 1
    s_branch SPIN_1
SPR_3:
SPD_2:
    ds_read_b64_tr_b16 v[44:45], v16 offset:0
    ds_read_b64_tr_b16 v[46:47], v16 offset:768
    ds_read_b64_tr_b16 v[48:49], v16 offset:64
    ds_read_b64_tr_b16 v[50:51], v16 offset:832
    ds_read_b64_tr_b16 v[52:53], v16 offset:128
    ds_read_b64_tr_b16 v[54:55], v16 offset:896
    ds_read_b64_tr_b16 v[56:57], v17 offset:0
    ds_read_b64_tr_b16 v[58:59], v17 offset:768
    ds_read_b64_tr_b16 v[60:61], v17 offset:64
    ds_read_b64_tr_b16 v[62:63], v17 offset:832
    ds_read_b64_tr_b16 v[64:65], v17 offset:128
    ds_read_b64_tr_b16 v[66:67], v17 offset:896
    s_waitcnt lgkmcnt(6)
    v_mfma_f32_16x16x32_bf16 v[80:83], v[44:47], v[128:131], 0
    ds_read_b64_tr_b16 v[68:69], v18 offset:0
    v_mfma_f32_16x16x32_bf16 v[88:91], v[44:47], v[132:135], 0
    ds_read_b64_tr_b16 v[70:71], v18 offset:768
    v_mfma_f32_16x16x32_bf16 v[96:99], v[48:51], v[128:131], 0
    s_add_u32 s77, s9, 6
    s_and_b32 s77, s77, 7
    s_mul_i32 s77, s77, 176128
    s_add_u32 m0, s13, 122880
    s_add_u32 s78, s77, s75
    buffer_load_dwordx4 v8, s[56:59], s78 offen offset:0 lds
    ds_read_b64_tr_b16 v[72:73], v18 offset:64
    v_mfma_f32_16x16x32_bf16 v[104:107], v[48:51], v[132:135], 0
    ds_read_b64_tr_b16 v[74:75], v18 offset:832
    v_mfma_f32_16x16x32_bf16 v[112:115], v[52:55], v[128:131], 0
    ds_read_b64_tr_b16 v[76:77], v18 offset:128
    v_mfma_f32_16x16x32_bf16 v[120:123], v[52:55], v[132:135], 0
    ds_read_b64_tr_b16 v[78:79], v18 offset:896
    v_mfma_f32_16x16x32_bf16 v[32:35], v[28:31], v[44:47], 0
    v_mfma_f32_16x16x32_bf16 v[36:39], v[28:31], v[48:51], 0
    v_mfma_f32_16x16x32_bf16 v[40:43], v[28:31], v[52:55], 0
    s_waitcnt lgkmcnt(6)
    v_mfma_f32_16x16x32_bf16 v[84:87], v[56:59], v[128:131], 0
    ds_read_b64_tr_b16 v[44:45], v19 offset:0
    v_mfma_f32_16x16x32_bf16 v[92:95], v[56:59], v[132:135], 0
    ds_read_b64_tr_b16 v[46:47], v19 offset:768
    v_mfma_f32_16x16x32_bf16 v[100:103], v[60:63], v[128:131], 0
    buffer_load_dwordx4 v9, s[56:59], s78 offen offset:1024 lds
    ds_read_b64_tr_b16 v[48:49], v19 offset:64
    v_mfma_f32_16x16x32_bf16 v[108:111], v[60:63], v[132:135], 0
    ds_read_b64_tr_b16 v[50:51], v19 offset:832
    v_mfma_f32_16x16x32_bf16 v[116:119], v[64:67], v[128:131], 0
    ds_read_b64_tr_b16 v[52:53], v19 offset:128
    v_mfma_f32_16x16x32_bf16 v[124:127], v[64:67], v[132:135], 0
    ds_read_b64_tr_b16 v[54:55], v19 offset:896
    s_waitcnt lgkmcnt(6)
    v_mfma_f32_16x16x32_bf16 v[80:83], v[68:71], v[136:139], v[80:83]
    ds_read_b64_tr_b16 v[56:57], v16 offset:12288
    v_mfma_f32_16x16x32_bf16 v[88:91], v[68:71], v[140:143], v[88:91]
    ds_read_b64_tr_b16 v[58:59], v16 offset:13056
    v_mfma_f32_16x16x32_bf16 v[96:99], v[72:75], v[136:139], v[96:99]
    buffer_load_dwordx4 v10, s[56:59], s78 offen offset:2048 lds
    ds_read_b64_tr_b16 v[60:61], v16 offset:12352
    v_mfma_f32_16x16x32_bf16 v[104:107], v[72:75], v[140:143], v[104:107]
    ds_read_b64_tr_b16 v[62:63], v16 offset:13120
    v_mfma_f32_16x16x32_bf16 v[112:115], v[76:79], v[136:139], v[112:115]
    ds_read_b64_tr_b16 v[64:65], v16 offset:12416
    v_mfma_f32_16x16x32_bf16 v[120:123], v[76:79], v[140:143], v[120:123]
    ds_read_b64_tr_b16 v[66:67], v16 offset:13184
    s_waitcnt lgkmcnt(6)
    v_mfma_f32_16x16x32_bf16 v[84:87], v[44:47], v[136:139], v[84:87]
    ds_read_b64_tr_b16 v[68:69], v17 offset:12288
    v_mfma_f32_16x16x32_bf16 v[92:95], v[44:47], v[140:143], v[92:95]
    ds_read_b64_tr_b16 v[70:71], v17 offset:13056
    v_mfma_f32_16x16x32_bf16 v[100:103], v[48:51], v[136:139], v[100:103]
    s_add_u32 s77, s9, 7
    s_and_b32 s77, s77, 7
    s_mul_i32 s77, s77, 176128
    s_add_u32 m0, s13, 135168
    s_add_u32 s78, s77, s75
    buffer_load_dwordx4 v8, s[56:59], s78 offen offset:0 lds
    ds_read_b64_tr_b16 v[72:73], v17 offset:12352
    v_mfma_f32_16x16x32_bf16 v[108:111], v[48:51], v[140:143], v[108:111]
    ds_read_b64_tr_b16 v[74:75], v17 offset:13120
    v_mfma_f32_16x16x32_bf16 v[116:119], v[52:55], v[136:139], v[116:119]
    ds_read_b64_tr_b16 v[76:77], v17 offset:12416
    v_mfma_f32_16x16x32_bf16 v[124:127], v[52:55], v[140:143], v[124:127]
    ds_read_b64_tr_b16 v[78:79], v17 offset:13184
    s_waitcnt lgkmcnt(6)
    v_mfma_f32_16x16x32_bf16 v[80:83], v[56:59], v[144:147], v[80:83]
    ds_read_b64_tr_b16 v[44:45], v18 offset:12288
    v_mfma_f32_16x16x32_bf16 v[88:91], v[56:59], v[148:151], v[88:91]
    ds_read_b64_tr_b16 v[46:47], v18 offset:13056
    v_mfma_f32_16x16x32_bf16 v[96:99], v[60:63], v[144:147], v[96:99]
    buffer_load_dwordx4 v9, s[56:59], s78 offen offset:1024 lds
    ds_read_b64_tr_b16 v[48:49], v18 offset:12352
    v_mfma_f32_16x16x32_bf16 v[104:107], v[60:63], v[148:151], v[104:107]
    ds_read_b64_tr_b16 v[50:51], v18 offset:13120
    v_mfma_f32_16x16x32_bf16 v[112:115], v[64:67], v[144:147], v[112:115]
    ds_read_b64_tr_b16 v[52:53], v18 offset:12416
    v_mfma_f32_16x16x32_bf16 v[120:123], v[64:67], v[148:151], v[120:123]
    ds_read_b64_tr_b16 v[54:55], v18 offset:13184
    v_mfma_f32_16x16x32_bf16 v[32:35], v[28:31], v[56:59], v[32:35]
    v_mfma_f32_16x16x32_bf16 v[36:39], v[28:31], v[60:63], v[36:39]
    v_mfma_f32_16x16x32_bf16 v[40:43], v[28:31], v[64:67], v[40:43]
    s_waitcnt lgkmcnt(6)
    v_mfma_f32_16x16x32_bf16 v[84:87], v[68:71], v[144:147], v[84:87]
    ds_read_b64_tr_b16 v[56:57], v19 offset:12288
    v_mfma_f32_16x16x32_bf16 v[92:95], v[68:71], v[148:151], v[92:95]
    ds_read_b64_tr_b16 v[58:59], v19 offset:13056
    v_mfma_f32_16x16x32_bf16 v[100:103], v[72:75], v[144:147], v[100:103]
    buffer_load_dwordx4 v10, s[56:59], s78 offen offset:2048 lds
    ds_read_b64_tr_b16 v[60:61], v19 offset:12352
    v_mfma_f32_16x16x32_bf16 v[108:111], v[72:75], v[148:151], v[108:111]
    ds_read_b64_tr_b16 v[62:63], v19 offset:13120
    v_mfma_f32_16x16x32_bf16 v[116:119], v[76:79], v[144:147], v[116:119]
    ds_read_b64_tr_b16 v[64:65], v19 offset:12416
    v_mfma_f32_16x16x32_bf16 v[124:127], v[76:79], v[148:151], v[124:127]
    ds_read_b64_tr_b16 v[66:67], v19 offset:13184
    ds_add_u32 v20, v21 offset:16
    s_waitcnt lgkmcnt(7)
    v_mfma_f32_16x16x32_bf16 v[80:83], v[44:47], v[152:155], v[80:83]
    ds_read_b64_tr_b16 v[68:69], v16 offset:24576
    v_mfma_f32_16x16x32_bf16 v[88:91], v[44:47], v[156:159], v[88:91]
    ds_read_b64_tr_b16 v[70:71], v16 offset:25344
    v_mfma_f32_16x16x32_bf16 v[96:99], v[48:51], v[152:155], v[96:99]
    ds_read_b64_tr_b16 v[72:73], v16 offset:24640
    v_mfma_f32_16x16x32_bf16 v[104:107], v[48:51], v[156:159], v[104:107]
    ds_read_b64_tr_b16 v[74:75], v16 offset:25408
    v_mfma_f32_16x16x32_bf16 v[112:115], v[52:55], v[152:155], v[112:115]
    ds_read_b64_tr_b16 v[76:77], v16 offset:24704
    v_mfma_f32_16x16x32_bf16 v[120:123], v[52:55], v[156:159], v[120:123]
    ds_read_b64_tr_b16 v[78:79], v16 offset:25472
    s_waitcnt lgkmcnt(6)
    v_mfma_f32_16x16x32_bf16 v[84:87], v[56:59], v[152:155], v[84:87]
    ds_read_b64_tr_b16 v[44:45], v17 offset:24576
    v_mfma_f32_16x16x32_bf16 v[92:95], v[56:59], v[156:159], v[92:95]
    ds_read_b64_tr_b16 v[46:47], v17 offset:25344
    v_mfma_f32_16x16x32_bf16 v[100:103], v[60:63], v[152:155], v[100:103]
    ds_read_b64_tr_b16 v[48:49], v17 offset:24640
    v_mfma_f32_16x16x32_bf16 v[108:111], v[60:63], v[156:159], v[108:111]
    ds_read_b64_tr_b16 v[50:51], v17 offset:25408
    v_mfma_f32_16x16x32_bf16 v[116:119], v[64:67], v[152:155], v[116:119]
    ds_read_b64_tr_b16 v[52:53], v17 offset:24704
    v_mfma_f32_16x16x32_bf16 v[124:127], v[64:67], v[156:159], v[124:127]
    ds_read_b64_tr_b16 v[54:55], v17 offset:25472
    s_waitcnt lgkmcnt(6)
    v_mfma_f32_16x16x32_bf16 v[80:83], v[68:71], v[160:163], v[80:83]
    ds_read_b64_tr_b16 v[56:57], v18 offset:24576
    v_mfma_f32_16x16x32_bf16 v[88:91], v[68:71], v[164:167], v[88:91]
    ds_read_b64_tr_b16 v[58:59], v18 offset:25344
    v_mfma_f32_16x16x32_bf16 v[96:99], v[72:75], v[160:163], v[96:99]
    ds_read_b64_tr_b16 v[60:61], v18 offset:24640
    v_mfma_f32_16x16x32_bf16 v[104:107], v[72:75], v[164:167], v[104:107]
    ds_read_b64_tr_b16 v[62:63], v18 offset:25408
    v_mfma_f32_16x16x32_bf16 v[112:115], v[76:79], v[160:163], v[112:115]
    ds_read_b64_tr_b16 v[64:65], v18 offset:24704
    v_mfma_f32_16x16x32_bf16 v[120:123], v[76:79], v[164:167], v[120:123]
    ds_read_b64_tr_b16 v[66:67], v18 offset:25472
    v_mfma_f32_16x16x32_bf16 v[32:35], v[28:31], v[68:71], v[32:35]
    v_mfma_f32_16x16x32_bf16 v[36:39], v[28:31], v[72:75], v[36:39]
    v_mfma_f32_16x16x32_bf16 v[40:43], v[28:31], v[76:79], v[40:43]
    s_waitcnt lgkmcnt(6)
    v_mfma_f32_16x16x32_bf16 v[84:87], v[44:47], v[160:163], v[84:87]
    ds_read_b64_tr_b16 v[68:69], v19 offset:24576
    v_mfma_f32_16x16x32_bf16 v[92:95], v[44:47], v[164:167], v[92:95]
    ds_read_b64_tr_b16 v[70:71], v19 offset:25344
    v_mfma_f32_16x16x32_bf16 v[100:103], v[48:51], v[160:163], v[100:103]
    ds_read_b64_tr_b16 v[72:73], v19 offset:24640
    v_mfma_f32_16x16x32_bf16 v[108:111], v[48:51], v[164:167], v[108:111]
    ds_read_b64_tr_b16 v[74:75], v19 offset:25408
    v_mfma_f32_16x16x32_bf16 v[116:119], v[52:55], v[160:163], v[116:119]
    ds_read_b64_tr_b16 v[76:77], v19 offset:24704
    v_mfma_f32_16x16x32_bf16 v[124:127], v[52:55], v[164:167], v[124:127]
    ds_read_b64_tr_b16 v[78:79], v19 offset:25472
    s_waitcnt lgkmcnt(6)
    v_mfma_f32_16x16x32_bf16 v[80:83], v[56:59], v[168:171], v[80:83]
    ds_read_b64_tr_b16 v[44:45], v16 offset:36864
    v_mfma_f32_16x16x32_bf16 v[88:91], v[56:59], v[172:175], v[88:91]
    ds_read_b64_tr_b16 v[46:47], v16 offset:37632
    v_mfma_f32_16x16x32_bf16 v[96:99], v[60:63], v[168:171], v[96:99]
    ds_read_b64_tr_b16 v[48:49], v16 offset:36928
    v_mfma_f32_16x16x32_bf16 v[104:107], v[60:63], v[172:175], v[104:107]
    ds_read_b64_tr_b16 v[50:51], v16 offset:37696
    v_mfma_f32_16x16x32_bf16 v[112:115], v[64:67], v[168:171], v[112:115]
    ds_read_b64_tr_b16 v[52:53], v16 offset:36992
    v_mfma_f32_16x16x32_bf16 v[120:123], v[64:67], v[172:175], v[120:123]
    ds_read_b64_tr_b16 v[54:55], v16 offset:37760
    s_waitcnt lgkmcnt(6)
    v_mfma_f32_16x16x32_bf16 v[84:87], v[68:71], v[168:171], v[84:87]
    ds_read_b64_tr_b16 v[56:57], v17 offset:36864
    v_mfma_f32_16x16x32_bf16 v[92:95], v[68:71], v[172:175], v[92:95]
    ds_read_b64_tr_b16 v[58:59], v17 offset:37632
    v_mfma_f32_16x16x32_bf16 v[100:103], v[72:75], v[168:171], v[100:103]
    ds_read_b64_tr_b16 v[60:61], v17 offset:36928
    v_mfma_f32_16x16x32_bf16 v[108:111], v[72:75], v[172:175], v[108:111]
    ds_read_b64_tr_b16 v[62:63], v17 offset:37696
    v_mfma_f32_16x16x32_bf16 v[116:119], v[76:79], v[168:171], v[116:119]
    ds_read_b64_tr_b16 v[64:65], v17 offset:36992
    v_mfma_f32_16x16x32_bf16 v[124:127], v[76:79], v[172:175], v[124:127]
    ds_read_b64_tr_b16 v[66:67], v17 offset:37760
    s_waitcnt vmcnt(0)
    ds_add_u32 v20, v21 offset:12
    s_waitcnt lgkmcnt(7)
    v_mfma_f32_16x16x32_bf16 v[80:83], v[44:47], v[176:179], v[80:83]
    ds_read_b64_tr_b16 v[68:69], v18 offset:36864
    v_mfma_f32_16x16x32_bf16 v[88:91], v[44:47], v[180:183], v[88:91]
    ds_read_b64_tr_b16 v[70:71], v18 offset:37632
    v_mfma_f32_16x16x32_bf16 v[96:99], v[48:51], v[176:179], v[96:99]
    ds_read_b64_tr_b16 v[72:73], v18 offset:36928
    v_mfma_f32_16x16x32_bf16 v[104:107], v[48:51], v[180:183], v[104:107]
    ds_read_b64_tr_b16 v[74:75], v18 offset:37696
    v_mfma_f32_16x16x32_bf16 v[112:115], v[52:55], v[176:179], v[112:115]
    ds_read_b64_tr_b16 v[76:77], v18 offset:36992
    v_mfma_f32_16x16x32_bf16 v[120:123], v[52:55], v[180:183], v[120:123]
    ds_read_b64_tr_b16 v[78:79], v18 offset:37760
    v_mfma_f32_16x16x32_bf16 v[32:35], v[28:31], v[44:47], v[32:35]
    v_mfma_f32_16x16x32_bf16 v[36:39], v[28:31], v[48:51], v[36:39]
    v_mfma_f32_16x16x32_bf16 v[40:43], v[28:31], v[52:55], v[40:43]
    ds_read_b32 v2, v20 offset:12
    s_waitcnt lgkmcnt(7)
    v_mfma_f32_16x16x32_bf16 v[84:87], v[56:59], v[176:179], v[84:87]
    ds_read_b64_tr_b16 v[44:45], v19 offset:36864
    v_mfma_f32_16x16x32_bf16 v[92:95], v[56:59], v[180:183], v[92:95]
    ds_read_b64_tr_b16 v[46:47], v19 offset:37632
    v_mfma_f32_16x16x32_bf16 v[100:103], v[60:63], v[176:179], v[100:103]
    ds_read_b64_tr_b16 v[48:49], v19 offset:36928
    v_mfma_f32_16x16x32_bf16 v[108:111], v[60:63], v[180:183], v[108:111]
    ds_read_b64_tr_b16 v[50:51], v19 offset:37696
    v_mfma_f32_16x16x32_bf16 v[116:119], v[64:67], v[176:179], v[116:119]
    ds_read_b64_tr_b16 v[52:53], v19 offset:36992
    v_mfma_f32_16x16x32_bf16 v[124:127], v[64:67], v[180:183], v[124:127]
    ds_read_b64_tr_b16 v[54:55], v19 offset:37760
    ds_add_u32 v20, v21 offset:20
    s_waitcnt lgkmcnt(7)
    v_mfma_f32_16x16x32_bf16 v[80:83], v[68:71], v[184:187], v[80:83]
    v_readfirstlane_b32 s80, v2
    s_cmp_eq_u32 s80, 4
    s_cbranch_scc1 WOK_4
    s_mov_b32 s76, 0x800000
SPIN_5:
    ds_read_b32 v2, v20 offset:12
    s_waitcnt lgkmcnt(0)
    v_readfirstlane_b32 s80, v2
    s_sub_u32 s76, s76, 1
    s_cbranch_scc1 SPR_7
    s_cmp_eq_u32 s80, 4
    s_cbranch_scc1 SPR_7
    s_sleep 1
    s_branch SPIN_5
SPR_7:
SPD_6:
WOK_4:
    v_add_u32 v16, 49152, v16
    v_add_u32 v17, 49152, v17
    v_add_u32 v18, 49152, v18
    v_add_u32 v19, 49152, v19
    ds_read_b64_tr_b16 v[56:57], v16 offset:0
    v_mfma_f32_16x16x32_bf16 v[88:91], v[68:71], v[188:191], v[88:91]
    ds_read_b64_tr_b16 v[58:59], v16 offset:768
    v_mfma_f32_16x16x32_bf16 v[96:99], v[72:75], v[184:187], v[96:99]
    s_add_u32 m0, s82, 49152
    s_add_u32 s78, s83, 0
    buffer_load_dwordx4 v14, s[60:63], s78 offen offset:0 lds
    ds_read_b64_tr_b16 v[60:61], v16 offset:64
    v_mfma_f32_16x16x32_bf16 v[104:107], v[72:75], v[188:191], v[104:107]
    ds_read_b64_tr_b16 v[62:63], v16 offset:832
    v_mfma_f32_16x16x32_bf16 v[112:115], v[76:79], v[184:187], v[112:115]
    ds_read_b64_tr_b16 v[64:65], v16 offset:128
    v_mfma_f32_16x16x32_bf16 v[120:123], v[76:79], v[188:191], v[120:123]
    ds_read_b64_tr_b16 v[66:67], v16 offset:896
    s_waitcnt lgkmcnt(6)
    v_mfma_f32_16x16x32_bf16 v[84:87], v[44:47], v[184:187], v[84:87]
    ds_read_b64_tr_b16 v[68:69], v16 offset:12288
    v_mfma_f32_16x16x32_bf16 v[92:95], v[44:47], v[188:191], v[92:95]
    ds_read_b64_tr_b16 v[70:71], v16 offset:13056
    v_mfma_f32_16x16x32_bf16 v[100:103], v[48:51], v[184:187], v[100:103]
    buffer_load_dwordx4 v15, s[60:63], s78 offen offset:1024 lds
    ds_read_b64_tr_b16 v[72:73], v16 offset:12352
    v_mfma_f32_16x16x32_bf16 v[108:111], v[48:51], v[188:191], v[108:111]
    ds_read_b64_tr_b16 v[74:75], v16 offset:13120
    v_mfma_f32_16x16x32_bf16 v[116:119], v[52:55], v[184:187], v[116:119]
    ds_read_b64_tr_b16 v[76:77], v16 offset:12416
    v_mfma_f32_16x16x32_bf16 v[124:127], v[52:55], v[188:191], v[124:127]
    ds_read_b64_tr_b16 v[78:79], v16 offset:13184
    s_waitcnt lgkmcnt(6)
    v_mfma_f32_16x16x32_bf16 v[80:83], v[56:59], v[192:195], v[80:83]
    ds_read_b64_tr_b16 v[44:45], v16 offset:24576
    v_mfma_f32_16x16x32_bf16 v[88:91], v[56:59], v[196:199], v[88:91]
    ds_read_b64_tr_b16 v[46:47], v16 offset:25344
    v_mfma_f32_16x16x32_bf16 v[96:99], v[60:63], v[192:195], v[96:99]
    buffer_load_dwordx4 v23, s[60:63], s78 offen offset:2048 lds
    ds_read_b64_tr_b16 v[48:49], v16 offset:24640
    v_mfma_f32_16x16x32_bf16 v[104:107], v[60:63], v[196:199], v[104:107]
    ds_read_b64_tr_b16 v[50:51], v16 offset:25408
    v_mfma_f32_16x16x32_bf16 v[112:115], v[64:67], v[192:195], v[112:115]
    ds_read_b64_tr_b16 v[52:53], v16 offset:24704
    v_mfma_f32_16x16x32_bf16 v[120:123], v[64:67], v[196:199], v[120:123]
    ds_read_b64_tr_b16 v[54:55], v16 offset:25472
    v_mfma_f32_16x16x32_bf16 v[32:35], v[28:31], v[56:59], v[32:35]
    v_mfma_f32_16x16x32_bf16 v[36:39], v[28:31], v[60:63], v[36:39]
    v_mfma_f32_16x16x32_bf16 v[40:43], v[28:31], v[64:67], v[40:43]
    s_waitcnt lgkmcnt(6)
    v_mfma_f32_16x16x32_bf16 v[80:83], v[68:71], v[208:211], v[80:83]
    ds_read_b64_tr_b16 v[56:57], v16 offset:36864
    v_mfma_f32_16x16x32_bf16 v[88:91], v[68:71], v[212:215], v[88:91]
    ds_read_b64_tr_b16 v[58:59], v16 offset:37632
    v_mfma_f32_16x16x32_bf16 v[96:99], v[72:75], v[208:211], v[96:99]
    s_add_u32 m0, s82, 52224
    s_add_u32 s78, s83, 24576
    buffer_load_dwordx4 v14, s[60:63], s78 offen offset:0 lds
    ds_read_b64_tr_b16 v[60:61], v16 offset:36928
    v_mfma_f32_16x16x32_bf16 v[104:107], v[72:75], v[212:215], v[104:107]
    ds_read_b64_tr_b16 v[62:63], v16 offset:37696
    v_mfma_f32_16x16x32_bf16 v[112:115], v[76:79], v[208:211], v[112:115]
    ds_read_b64_tr_b16 v[64:65], v16 offset:36992
    v_mfma_f32_16x16x32_bf16 v[120:123], v[76:79], v[212:215], v[120:123]
    ds_read_b64_tr_b16 v[66:67], v16 offset:37760
    v_mfma_f32_16x16x32_bf16 v[32:35], v[28:31], v[68:71], v[32:35]
    v_mfma_f32_16x16x32_bf16 v[36:39], v[28:31], v[72:75], v[36:39]
    v_mfma_f32_16x16x32_bf16 v[40:43], v[28:31], v[76:79], v[40:43]
    ds_read_b32 v2, v20 offset:20
    s_waitcnt lgkmcnt(7)
    v_mfma_f32_16x16x32_bf16 v[80:83], v[44:47], v[224:227], v[80:83]
    ds_read_b64_tr_b16 v[68:69], v17 offset:0
    v_mfma_f32_16x16x32_bf16 v[88:91], v[44:47], v[228:231], v[88:91]
    ds_read_b64_tr_b16 v[70:71], v17 offset:768
    v_mfma_f32_16x16x32_bf16 v[96:99], v[48:51], v[224:227], v[96:99]
    buffer_load_dwordx4 v15, s[60:63], s78 offen offset:1024 lds
    ds_read_b64_tr_b16 v[72:73], v17 offset:64
    v_mfma_f32_16x16x32_bf16 v[104:107], v[48:51], v[228:231], v[104:107]
    ds_read_b64_tr_b16 v[74:75], v17 offset:832
    v_mfma_f32_16x16x32_bf16 v[112:115], v[52:55], v[224:227], v[112:115]
    ds_read_b64_tr_b16 v[76:77], v17 offset:128
    v_mfma_f32_16x16x32_bf16 v[120:123], v[52:55], v[228:231], v[120:123]
    ds_read_b64_tr_b16 v[78:79], v17 offset:896
    v_mfma_f32_16x16x32_bf16 v[32:35], v[28:31], v[44:47], v[32:35]
    v_mfma_f32_16x16x32_bf16 v[36:39], v[28:31], v[48:51], v[36:39]
    v_mfma_f32_16x16x32_bf16 v[40:43], v[28:31], v[52:55], v[40:43]
    s_waitcnt lgkmcnt(6)
    v_mfma_f32_16x16x32_bf16 v[80:83], v[56:59], v[240:243], v[80:83]
    v_readfirstlane_b32 s80, v2
    s_cmp_eq_u32 s80, 4
    s_cbranch_scc1 WOK_8
    s_mov_b32 s76, 0x800000
SPIN_9:
    ds_read_b32 v2, v20 offset:20
    s_waitcnt lgkmcnt(0)
    v_readfirstlane_b32 s80, v2
    s_sub_u32 s76, s76, 1
    s_cbranch_scc1 SPR_11
    s_cmp_eq_u32 s80, 4
    s_cbranch_scc1 SPR_11
    s_sleep 1
    s_branch SPIN_9
SPR_11:
SPD_10:
WOK_8:
    ds_read_b64_tr_b16 v[44:45], v18 offset:0
    v_mfma_f32_16x16x32_bf16 v[88:91], v[56:59], v[244:247], v[88:91]
    ds_read_b64_tr_b16 v[46:47], v18 offset:768
    v_mfma_f32_16x16x32_bf16 v[96:99], v[60:63], v[240:243], v[96:99]
    buffer_load_dwordx4 v23, s[60:63], s78 offen offset:2048 lds
    ds_read_b64_tr_b16 v[48:49], v18 offset:64
    v_mfma_f32_16x16x32_bf16 v[104:107], v[60:63], v[244:247], v[104:107]
    ds_read_b64_tr_b16 v[50:51], v18 offset:832
    v_mfma_f32_16x16x32_bf16 v[112:115], v[64:67], v[240:243], v[112:115]
    ds_read_b64_tr_b16 v[52:53], v18 offset:128
    v_mfma_f32_16x16x32_bf16 v[120:123], v[64:67], v[244:247], v[120:123]
    ds_read_b64_tr_b16 v[54:55], v18 offset:896
    v_mfma_f32_16x16x32_bf16 v[32:35], v[28:31], v[56:59], v[32:35]
    v_mfma_f32_16x16x32_bf16 v[36:39], v[28:31], v[60:63], v[36:39]
    v_mfma_f32_16x16x32_bf16 v[40:43], v[28:31], v[64:67], v[40:43]
    s_waitcnt lgkmcnt(6)
    v_mfma_f32_16x16x32_bf16 v[84:87], v[68:71], v[192:195], v[84:87]
    ds_read_b64_tr_b16 v[56:57], v19 offset:0
    v_mfma_f32_16x16x32_bf16 v[92:95], v[68:71], v[196:199], v[92:95]
    ds_read_b64_tr_b16 v[58:59], v19 offset:768
    v_mfma_f32_16x16x32_bf16 v[100:103], v[72:75], v[192:195], v[100:103]
    s_add_u32 m0, s82, 73728
    s_add_u32 s78, s83, 360448
    buffer_load_dwordx4 v14, s[60:63], s78 offen offset:0 lds
    ds_read_b64_tr_b16 v[60:61], v19 offset:64
    v_mfma_f32_16x16x32_bf16 v[108:111], v[72:75], v[196:199], v[108:111]
    ds_read_b64_tr_b16 v[62:63], v19 offset:832
    v_mfma_f32_16x16x32_bf16 v[116:119], v[76:79], v[192:195], v[116:119]
    ds_read_b64_tr_b16 v[64:65], v19 offset:128
    v_mfma_f32_16x16x32_bf16 v[124:127], v[76:79], v[196:199], v[124:127]
    ds_read_b64_tr_b16 v[66:67], v19 offset:896
    ds_read_b32 v2, v20 offset:0
    ds_read2_b32 v[140:141], v26 offset0:0 offset1:16
    ds_read2_b32 v[144:145], v26 offset0:128 offset1:128
    ds_read2_b32 v[148:149], v26 offset0:144 offset1:144
    s_waitcnt lgkmcnt(10)
    v_mfma_f32_16x16x32_bf16 v[80:83], v[44:47], v[200:203], v[80:83]
    ds_read_b64_tr_b16 v[68:69], v17 offset:12288
    v_mfma_f32_16x16x32_bf16 v[88:91], v[44:47], v[204:207], v[88:91]
    ds_read_b64_tr_b16 v[70:71], v17 offset:13056
    v_mfma_f32_16x16x32_bf16 v[96:99], v[48:51], v[200:203], v[96:99]
    buffer_load_dwordx4 v15, s[60:63], s78 offen offset:1024 lds
    ds_read_b64_tr_b16 v[72:73], v17 offset:12352
    v_mfma_f32_16x16x32_bf16 v[104:107], v[48:51], v[204:207], v[104:107]
    ds_read_b64_tr_b16 v[74:75], v17 offset:13120
    v_mfma_f32_16x16x32_bf16 v[112:115], v[52:55], v[200:203], v[112:115]
    ds_read_b64_tr_b16 v[76:77], v17 offset:12416
    v_mfma_f32_16x16x32_bf16 v[120:123], v[52:55], v[204:207], v[120:123]
    ds_read_b64_tr_b16 v[78:79], v17 offset:13184
    ds_write_b32 v1, v32 offset:0
    ds_write_b32 v1, v36 offset:1024
    ds_write_b32 v1, v40 offset:2048
    ds_add_u32 v20, v21 offset:56
    s_waitcnt lgkmcnt(10)
    v_mfma_f32_16x16x32_bf16 v[84:87], v[56:59], v[200:203], v[84:87]
    v_readfirstlane_b32 s80, v2
    s_cmp_eq_u32 s80, 8
    s_cbranch_scc1 WOK_12
    ds_read_b32 v2, v20 offset:0
    ds_read2_b32 v[140:141], v26 offset0:0 offset1:16
    ds_read2_b32 v[144:145], v26 offset0:128 offset1:128
    ds_read2_b32 v[148:149], v26 offset0:144 offset1:144
    s_waitcnt lgkmcnt(0)
    v_readfirstlane_b32 s80, v2
    s_cmp_eq_u32 s80, 8
    s_cbranch_scc1 SPD_14
    s_mov_b32 s76, 0x800000
SPIN_13:
    ds_read_b32 v2, v20 offset:0
    s_waitcnt lgkmcnt(0)
    v_readfirstlane_b32 s80, v2
    s_sub_u32 s76, s76, 1
    s_cbranch_scc1 SPR_15
    s_cmp_eq_u32 s80, 8
    s_cbranch_scc1 SPR_15
    s_sleep 1
    s_branch SPIN_13
SPR_15:
    ds_read2_b32 v[140:141], v26 offset0:0 offset1:16
    ds_read2_b32 v[144:145], v26 offset0:128 offset1:128
    ds_read2_b32 v[148:149], v26 offset0:144 offset1:144
    s_waitcnt lgkmcnt(0)
SPD_14:
WOK_12:
    ds_read_b64_tr_b16 v[44:45], v18 offset:12288
    v_mfma_f32_16x16x32_bf16 v[92:95], v[56:59], v[204:207], v[92:95]
    ds_read_b64_tr_b16 v[46:47], v18 offset:13056
    v_and_b32 v130, s33, v140
    v_mfma_f32_16x16x32_bf16 v[100:103], v[60:63], v[200:203], v[100:103]
    buffer_load_dwordx4 v23, s[60:63], s78 offen offset:2048 lds
    ds_read_b64_tr_b16 v[48:49], v18 offset:12352
    v_mfma_f32_16x16x32_bf16 v[108:111], v[60:63], v[204:207], v[108:111]
    ds_read_b64_tr_b16 v[50:51], v18 offset:13120
    v_xor_b32 v128, v130, v140
    v_mfma_f32_16x16x32_bf16 v[116:119], v[64:67], v[200:203], v[116:119]
    ds_read_b64_tr_b16 v[52:53], v18 offset:12416
    v_mfma_f32_16x16x32_bf16 v[124:127], v[64:67], v[204:207], v[124:127]
    ds_read_b64_tr_b16 v[54:55], v18 offset:13184
    v_mov_b32 v131, v130
    s_waitcnt lgkmcnt(6)
    v_mfma_f32_16x16x32_bf16 v[84:87], v[68:71], v[208:211], v[84:87]
    ds_read_b64_tr_b16 v[56:57], v19 offset:12288
    v_mfma_f32_16x16x32_bf16 v[92:95], v[68:71], v[212:215], v[92:95]
    ds_read_b64_tr_b16 v[58:59], v19 offset:13056
    v_mov_b32 v129, v128
    v_mfma_f32_16x16x32_bf16 v[100:103], v[72:75], v[208:211], v[100:103]
    s_add_u32 m0, s82, 76800
    s_add_u32 s78, s83, 385024
    buffer_load_dwordx4 v14, s[60:63], s78 offen offset:0 lds
    ds_read_b64_tr_b16 v[60:61], v19 offset:12352
    v_mfma_f32_16x16x32_bf16 v[108:111], v[72:75], v[212:215], v[108:111]
    ds_read_b64_tr_b16 v[62:63], v19 offset:13120
    v_mov_b32 v132, v128
    v_mfma_f32_16x16x32_bf16 v[116:119], v[76:79], v[208:211], v[116:119]
    ds_read_b64_tr_b16 v[64:65], v19 offset:12416
    v_mfma_f32_16x16x32_bf16 v[124:127], v[76:79], v[212:215], v[124:127]
    ds_read_b64_tr_b16 v[66:67], v19 offset:13184
    v_mov_b32 v133, v128
    ds_add_u32 v20, v21 offset:24
    s_waitcnt lgkmcnt(7)
    v_mfma_f32_16x16x32_bf16 v[80:83], v[44:47], v[216:219], v[80:83]
    ds_read_b64_tr_b16 v[68:69], v17 offset:24576
    v_mfma_f32_16x16x32_bf16 v[88:91], v[44:47], v[220:223], v[88:91]
    ds_read_b64_tr_b16 v[70:71], v17 offset:25344
    v_and_b32 v136, s33, v141
    v_mfma_f32_16x16x32_bf16 v[96:99], v[48:51], v[216:219], v[96:99]
    buffer_load_dwordx4 v15, s[60:63], s78 offen offset:1024 lds
    ds_read_b64_tr_b16 v[72:73], v17 offset:24640
    v_mfma_f32_16x16x32_bf16 v[104:107], v[48:51], v[220:223], v[104:107]
    ds_read_b64_tr_b16 v[74:75], v17 offset:25408
    v_xor_b32 v134, v136, v141
    v_mfma_f32_16x16x32_bf16 v[112:115], v[52:55], v[216:219], v[112:115]
    ds_read_b64_tr_b16 v[76:77], v17 offset:24704
    v_mfma_f32_16x16x32_bf16 v[120:123], v[52:55], v[220:223], v[120:123]
    ds_read_b64_tr_b16 v[78:79], v17 offset:25472
    v_mov_b32 v137, v136
    ds_read_b32 v2, v20 offset:56
    ds_read_b128 v[32:35], v25 offset:0
    ds_read_b128 v[36:39], v25 offset:1024
    ds_read_b128 v[40:43], v25 offset:2048
    s_waitcnt lgkmcnt(10)
    v_mfma_f32_16x16x32_bf16 v[84:87], v[56:59], v[216:219], v[84:87]
    ds_read_b64_tr_b16 v[44:45], v18 offset:24576
    v_mfma_f32_16x16x32_bf16 v[92:95], v[56:59], v[220:223], v[92:95]
    ds_read_b64_tr_b16 v[46:47], v18 offset:25344
    v_mov_b32 v135, v134
    v_mfma_f32_16x16x32_bf16 v[100:103], v[60:63], v[216:219], v[100:103]
    buffer_load_dwordx4 v23, s[60:63], s78 offen offset:2048 lds
    ds_read_b64_tr_b16 v[48:49], v18 offset:24640
    v_mfma_f32_16x16x32_bf16 v[108:111], v[60:63], v[220:223], v[108:111]
    ds_read_b64_tr_b16 v[50:51], v18 offset:25408
    v_mov_b32 v138, v134
    v_mfma_f32_16x16x32_bf16 v[116:119], v[64:67], v[216:219], v[116:119]
    ds_read_b64_tr_b16 v[52:53], v18 offset:24704
    v_mfma_f32_16x16x32_bf16 v[124:127], v[64:67], v[220:223], v[124:127]
    ds_read_b64_tr_b16 v[54:55], v18 offset:25472
    v_mov_b32 v139, v134
    ds_read_b32 v3, v20 offset:24
    s_waitcnt lgkmcnt(7)
    v_mfma_f32_16x16x32_bf16 v[84:87], v[68:71], v[224:227], v[84:87]
    v_readfirstlane_b32 s80, v2
    s_cmp_eq_u32 s80, 4
    s_cbranch_scc1 WOK_16
    ds_read_b32 v2, v20 offset:56
    ds_read_b128 v[32:35], v25 offset:0
    ds_read_b128 v[36:39], v25 offset:1024
    ds_read_b128 v[40:43], v25 offset:2048
    s_waitcnt lgkmcnt(0)
    v_readfirstlane_b32 s80, v2
    s_cmp_eq_u32 s80, 4
    s_cbranch_scc1 SPD_18
    s_mov_b32 s76, 0x800000
SPIN_17:
    ds_read_b32 v2, v20 offset:56
    s_waitcnt lgkmcnt(0)
    v_readfirstlane_b32 s80, v2
    s_sub_u32 s76, s76, 1
    s_cbranch_scc1 SPR_19
    s_cmp_eq_u32 s80, 4
    s_cbranch_scc1 SPR_19
    s_sleep 1
    s_branch SPIN_17
SPR_19:
    ds_read_b128 v[32:35], v25 offset:0
    ds_read_b128 v[36:39], v25 offset:1024
    ds_read_b128 v[40:43], v25 offset:2048
    s_waitcnt lgkmcnt(0)
SPD_18:
WOK_16:
    ds_read_b64_tr_b16 v[56:57], v19 offset:24576
    v_add_f32 v33, v32, v33
    v_add_f32 v35, v34, v35
    v_mfma_f32_16x16x32_bf16 v[92:95], v[68:71], v[228:231], v[92:95]
    ds_read_b64_tr_b16 v[58:59], v19 offset:25344
    v_and_b32 v4, 0xffff0000, v33
    v_sub_f32 v4, v33, v4
    v_mfma_f32_16x16x32_bf16 v[100:103], v[72:75], v[224:227], v[100:103]
    ds_read_b64_tr_b16 v[60:61], v19 offset:24640
    v_perm_b32 v32, v4, v33, s84
    v_and_b32 v33, 0xffff0000, v4
    v_mfma_f32_16x16x32_bf16 v[108:111], v[72:75], v[228:231], v[108:111]
    ds_read_b64_tr_b16 v[62:63], v19 offset:25408
    v_sub_f32 v4, v4, v33
    v_lshrrev_b32 v33, 16, v4
    v_mfma_f32_16x16x32_bf16 v[116:119], v[76:79], v[224:227], v[116:119]
    ds_read_b64_tr_b16 v[64:65], v19 offset:24704
    v_and_b32 v5, 0xffff0000, v35
    v_sub_f32 v5, v35, v5
    v_mfma_f32_16x16x32_bf16 v[124:127], v[76:79], v[228:231], v[124:127]
    ds_read_b64_tr_b16 v[66:67], v19 offset:25472
    v_perm_b32 v34, v5, v35, s84
    v_and_b32 v35, 0xffff0000, v5
    s_waitcnt lgkmcnt(6)
    v_mfma_f32_16x16x32_bf16 v[80:83], v[44:47], v[232:235], v[80:83]
    v_readfirstlane_b32 s80, v3
    s_cmp_eq_u32 s80, 4
    s_cbranch_scc1 WOK_20
    s_mov_b32 s76, 0x800000
SPIN_21:
    ds_read_b32 v3, v20 offset:24
    s_waitcnt lgkmcnt(0)
    v_readfirstlane_b32 s80, v3
    s_sub_u32 s76, s76, 1
    s_cbranch_scc1 SPR_23
    s_cmp_eq_u32 s80, 4
    s_cbranch_scc1 SPR_23
    s_sleep 1
    s_branch SPIN_21
SPR_23:
SPD_22:
WOK_20:
    ds_read_b64_tr_b16 v[68:69], v17 offset:36864
    v_sub_f32 v5, v5, v35
    v_lshrrev_b32 v35, 16, v5
    v_mfma_f32_16x16x32_bf16 v[88:91], v[44:47], v[236:239], v[88:91]
    ds_read_b64_tr_b16 v[70:71], v17 offset:37632
    v_add_f32 v37, v36, v37
    v_add_f32 v39, v38, v39
    v_mfma_f32_16x16x32_bf16 v[96:99], v[48:51], v[232:235], v[96:99]
    s_add_u32 m0, s82, 98304
    s_add_u32 s78, s83, 720896
    buffer_load_dwordx4 v14, s[60:63], s78 offen offset:0 lds
    ds_read_b64_tr_b16 v[72:73], v17 offset:36928
    v_and_b32 v4, 0xffff0000, v37
    v_sub_f32 v4, v37, v4
    v_mfma_f32_16x16x32_bf16 v[104:107], v[48:51], v[236:239], v[104:107]
    ds_read_b64_tr_b16 v[74:75], v17 offset:37696
    v_perm_b32 v36, v4, v37, s84
    v_and_b32 v37, 0xffff0000, v4
    v_mfma_f32_16x16x32_bf16 v[112:115], v[52:55], v[232:235], v[112:115]
    ds_read_b64_tr_b16 v[76:77], v17 offset:36992
    v_sub_f32 v4, v4, v37
    v_lshrrev_b32 v37, 16, v4
    v_mfma_f32_16x16x32_bf16 v[120:123], v[52:55], v[236:239], v[120:123]
    ds_read_b64_tr_b16 v[78:79], v17 offset:37760
    v_and_b32 v5, 0xffff0000, v39
    v_sub_f32 v5, v39, v5
    s_waitcnt lgkmcnt(6)
    v_mfma_f32_16x16x32_bf16 v[84:87], v[56:59], v[232:235], v[84:87]
    ds_read_b64_tr_b16 v[44:45], v18 offset:36864
    v_perm_b32 v38, v5, v39, s84
    v_and_b32 v39, 0xffff0000, v5
    v_mfma_f32_16x16x32_bf16 v[92:95], v[56:59], v[236:239], v[92:95]
    ds_read_b64_tr_b16 v[46:47], v18 offset:37632
    v_sub_f32 v5, v5, v39
    v_lshrrev_b32 v39, 16, v5
    v_mfma_f32_16x16x32_bf16 v[100:103], v[60:63], v[232:235], v[100:103]
    buffer_load_dwordx4 v15, s[60:63], s78 offen offset:1024 lds
    ds_read_b64_tr_b16 v[48:49], v18 offset:36928
    v_add_f32 v41, v40, v41
    v_add_f32 v43, v42, v43
    v_mfma_f32_16x16x32_bf16 v[108:111], v[60:63], v[236:239], v[108:111]
    ds_read_b64_tr_b16 v[50:51], v18 offset:37696
    v_and_b32 v4, 0xffff0000, v41
    v_sub_f32 v4, v41, v4
    v_mfma_f32_16x16x32_bf16 v[116:119], v[64:67], v[232:235], v[116:119]
    ds_read_b64_tr_b16 v[52:53], v18 offset:36992
    v_perm_b32 v40, v4, v41, s84
    v_and_b32 v41, 0xffff0000, v4
    v_mfma_f32_16x16x32_bf16 v[124:127], v[64:67], v[236:239], v[124:127]
    ds_read_b64_tr_b16 v[54:55], v18 offset:37760
    v_sub_f32 v4, v4, v41
    v_lshrrev_b32 v41, 16, v4
    s_waitcnt lgkmcnt(6)
    v_mfma_f32_16x16x32_bf16 v[84:87], v[68:71], v[240:243], v[84:87]
    ds_read_b64_tr_b16 v[56:57], v19 offset:36864
    v_and_b32 v5, 0xffff0000, v43
    v_sub_f32 v5, v43, v5
    v_mfma_f32_16x16x32_bf16 v[92:95], v[68:71], v[244:247], v[92:95]
    ds_read_b64_tr_b16 v[58:59], v19 offset:37632
    v_perm_b32 v42, v5, v43, s84
    v_and_b32 v43, 0xffff0000, v5
    v_mfma_f32_16x16x32_bf16 v[100:103], v[72:75], v[240:243], v[100:103]
    buffer_load_dwordx4 v23, s[60:63], s78 offen offset:2048 lds
    ds_read_b64_tr_b16 v[60:61], v19 offset:36928
    v_sub_f32 v5, v5, v43
    v_lshrrev_b32 v43, 16, v5
    v_mfma_f32_16x16x32_bf16 v[108:111], v[72:75], v[244:247], v[108:111]
    ds_read_b64_tr_b16 v[62:63], v19 offset:37696
    v_mfma_f32_16x16x32_bf16 v[116:119], v[76:79], v[240:243], v[116:119]
    ds_read_b64_tr_b16 v[64:65], v19 offset:36992
    v_mfma_f32_16x16x32_bf16 v[124:127], v[76:79], v[244:247], v[124:127]
    ds_read_b64_tr_b16 v[66:67], v19 offset:37760
    ds_add_u32 v20, v21 offset:28
    s_waitcnt lgkmcnt(7)
    v_mfma_f32_16x16x32_bf16 v[80:83], v[44:47], v[248:251], v[80:83]
    v_mfma_f32_16x16x32_bf16 v[84:87], v[32:35], v[130:133], v[84:87]
    v_mfma_f32_16x16x32_bf16 v[88:91], v[44:47], v[252:255], v[88:91]
    v_mfma_f32_16x16x32_bf16 v[92:95], v[32:35], v[136:139], v[92:95]
    v_mfma_f32_16x16x32_bf16 v[96:99], v[48:51], v[248:251], v[96:99]
    s_add_u32 m0, s82, 101376
    s_add_u32 s78, s83, 745472
    buffer_load_dwordx4 v14, s[60:63], s78 offen offset:0 lds
    v_mfma_f32_16x16x32_bf16 v[100:103], v[36:39], v[130:133], v[100:103]
    v_mfma_f32_16x16x32_bf16 v[104:107], v[48:51], v[252:255], v[104:107]
    v_mfma_f32_16x16x32_bf16 v[108:111], v[36:39], v[136:139], v[108:111]
    v_mfma_f32_16x16x32_bf16 v[112:115], v[52:55], v[248:251], v[112:115]
    v_mfma_f32_16x16x32_bf16 v[116:119], v[40:43], v[130:133], v[116:119]
    v_mfma_f32_16x16x32_bf16 v[120:123], v[52:55], v[252:255], v[120:123]
    v_mfma_f32_16x16x32_bf16 v[124:127], v[40:43], v[136:139], v[124:127]
    s_waitcnt lgkmcnt(0)
    v_mfma_f32_16x16x32_bf16 v[84:87], v[56:59], v[248:251], v[84:87]
    v_mfma_f32_16x16x32_bf16 v[80:83], v[32:35], v[128:131], v[80:83]
    v_mfma_f32_16x16x32_bf16 v[92:95], v[56:59], v[252:255], v[92:95]
    v_mfma_f32_16x16x32_bf16 v[88:91], v[32:35], v[134:137], v[88:91]
    v_mfma_f32_16x16x32_bf16 v[100:103], v[60:63], v[248:251], v[100:103]
    buffer_load_dwordx4 v15, s[60:63], s78 offen offset:1024 lds
    v_mfma_f32_16x16x32_bf16 v[96:99], v[36:39], v[128:131], v[96:99]
    v_mfma_f32_16x16x32_bf16 v[108:111], v[60:63], v[252:255], v[108:111]
    v_mfma_f32_16x16x32_bf16 v[104:107], v[36:39], v[134:137], v[104:107]
    v_mfma_f32_16x16x32_bf16 v[116:119], v[64:67], v[248:251], v[116:119]
    buffer_load_dwordx4 v23, s[60:63], s78 offen offset:2048 lds
    v_mfma_f32_16x16x32_bf16 v[112:115], v[40:43], v[128:131], v[112:115]
    v_mfma_f32_16x16x32_bf16 v[124:127], v[64:67], v[252:255], v[124:127]
    v_mfma_f32_16x16x32_bf16 v[120:123], v[40:43], v[134:137], v[120:123]
    v_mul_f32 v146, 0xbfb8aa3b, v144
    v_mul_f32 v147, 0xbfb8aa3b, v144
    v_mul_f32 v150, 0xbfb8aa3b, v148
    v_mul_f32 v151, 0xbfb8aa3b, v148
    s_setprio 3
    s_add_u32 s32, s79, 4096
    v_pk_mul_f32 v[44:45], v[80:81], v[146:147]
    v_pk_mul_f32 v[46:47], v[82:83], v[146:147]
    v_pk_mul_f32 v[48:49], v[84:85], v[146:147]
    v_pk_mul_f32 v[50:51], v[86:87], v[146:147]
    v_exp_f32 v44, v44
    v_exp_f32 v45, v45
    v_pk_mul_f32 v[80:81], v[80:81], v[144:145]
    v_exp_f32 v46, v46
    v_exp_f32 v47, v47
    v_pk_mul_f32 v[82:83], v[82:83], v[144:145]
    v_exp_f32 v48, v48
    v_exp_f32 v49, v49
    v_pk_mul_f32 v[84:85], v[84:85], v[144:145]
    v_exp_f32 v50, v50
    v_exp_f32 v51, v51
    v_pk_mul_f32 v[86:87], v[86:87], v[144:145]
    v_pk_add_f32 v[44:45], v[44:45], 1.0 op_sel_hi:[1,0]
    v_pk_add_f32 v[46:47], v[46:47], 1.0 op_sel_hi:[1,0]
    v_pk_add_f32 v[48:49], v[48:49], 1.0 op_sel_hi:[1,0]
    v_pk_add_f32 v[50:51], v[50:51], 1.0 op_sel_hi:[1,0]
    v_rcp_f32 v44, v44
    v_rcp_f32 v45, v45
    v_rcp_f32 v46, v46
    v_rcp_f32 v47, v47
    v_rcp_f32 v48, v48
    v_rcp_f32 v49, v49
    v_rcp_f32 v50, v50
    v_rcp_f32 v51, v51
    v_pk_mul_f32 v[80:81], v[80:81], v[44:45]
    v_pk_mul_f32 v[82:83], v[82:83], v[46:47]
    v_pk_mul_f32 v[84:85], v[84:85], v[48:49]
    v_pk_mul_f32 v[86:87], v[86:87], v[50:51]
    v_cvt_pk_bf16_f32 v80, v80, v81
    v_cvt_pk_bf16_f32 v81, v82, v83
    v_cvt_pk_bf16_f32 v82, v84, v85
    v_cvt_pk_bf16_f32 v83, v86, v87
    buffer_store_dwordx4 v[80:83], v27, s[64:67], s79 offen offset:0 sc1
    v_pk_mul_f32 v[52:53], v[88:89], v[150:151]
    v_pk_mul_f32 v[54:55], v[90:91], v[150:151]
    v_pk_mul_f32 v[56:57], v[92:93], v[150:151]
    v_pk_mul_f32 v[58:59], v[94:95], v[150:151]
    v_exp_f32 v52, v52
    v_exp_f32 v53, v53
    v_pk_mul_f32 v[88:89], v[88:89], v[148:149]
    v_exp_f32 v54, v54
    v_exp_f32 v55, v55
    v_pk_mul_f32 v[90:91], v[90:91], v[148:149]
    v_exp_f32 v56, v56
    v_exp_f32 v57, v57
    v_pk_mul_f32 v[92:93], v[92:93], v[148:149]
    v_exp_f32 v58, v58
    v_exp_f32 v59, v59
    v_pk_mul_f32 v[94:95], v[94:95], v[148:149]
    v_pk_add_f32 v[52:53], v[52:53], 1.0 op_sel_hi:[1,0]
    v_pk_add_f32 v[54:55], v[54:55], 1.0 op_sel_hi:[1,0]
    v_pk_add_f32 v[56:57], v[56:57], 1.0 op_sel_hi:[1,0]
    v_pk_add_f32 v[58:59], v[58:59], 1.0 op_sel_hi:[1,0]
    v_rcp_f32 v52, v52
    v_rcp_f32 v53, v53
    v_rcp_f32 v54, v54
    v_rcp_f32 v55, v55
    v_rcp_f32 v56, v56
    v_rcp_f32 v57, v57
    v_rcp_f32 v58, v58
    v_rcp_f32 v59, v59
    v_pk_mul_f32 v[88:89], v[88:89], v[52:53]
    v_pk_mul_f32 v[90:91], v[90:91], v[54:55]
    v_pk_mul_f32 v[92:93], v[92:93], v[56:57]
    v_pk_mul_f32 v[94:95], v[94:95], v[58:59]
    v_cvt_pk_bf16_f32 v88, v88, v89
    v_cvt_pk_bf16_f32 v89, v90, v91
    v_cvt_pk_bf16_f32 v90, v92, v93
    v_cvt_pk_bf16_f32 v91, v94, v95
    buffer_store_dwordx4 v[88:91], v27, s[64:67], s79 offen offset:256 sc1
    s_cmp_eq_u32 s6, 15
    s_cbranch_scc1 NOT2_24
    v_pk_mul_f32 v[44:45], v[96:97], v[146:147]
    v_pk_mul_f32 v[46:47], v[98:99], v[146:147]
    v_pk_mul_f32 v[48:49], v[100:101], v[146:147]
    v_pk_mul_f32 v[50:51], v[102:103], v[146:147]
    v_exp_f32 v44, v44
    v_exp_f32 v45, v45
    v_pk_mul_f32 v[96:97], v[96:97], v[144:145]
    v_exp_f32 v46, v46
    v_exp_f32 v47, v47
    v_pk_mul_f32 v[98:99], v[98:99], v[144:145]
    v_exp_f32 v48, v48
    v_exp_f32 v49, v49
    v_pk_mul_f32 v[100:101], v[100:101], v[144:145]
    v_exp_f32 v50, v50
    v_exp_f32 v51, v51
    v_pk_mul_f32 v[102:103], v[102:103], v[144:145]
    v_pk_add_f32 v[44:45], v[44:45], 1.0 op_sel_hi:[1,0]
    v_pk_add_f32 v[46:47], v[46:47], 1.0 op_sel_hi:[1,0]
    v_pk_add_f32 v[48:49], v[48:49], 1.0 op_sel_hi:[1,0]
    v_pk_add_f32 v[50:51], v[50:51], 1.0 op_sel_hi:[1,0]
    v_rcp_f32 v44, v44
    v_rcp_f32 v45, v45
    v_rcp_f32 v46, v46
    v_rcp_f32 v47, v47
    v_rcp_f32 v48, v48
    v_rcp_f32 v49, v49
    v_rcp_f32 v50, v50
    v_rcp_f32 v51, v51
    v_pk_mul_f32 v[96:97], v[96:97], v[44:45]
    v_pk_mul_f32 v[98:99], v[98:99], v[46:47]
    v_pk_mul_f32 v[100:101], v[100:101], v[48:49]
    v_pk_mul_f32 v[102:103], v[102:103], v[50:51]
    v_cvt_pk_bf16_f32 v96, v96, v97
    v_cvt_pk_bf16_f32 v97, v98, v99
    v_cvt_pk_bf16_f32 v98, v100, v101
    v_cvt_pk_bf16_f32 v99, v102, v103
    buffer_store_dwordx4 v[96:99], v27, s[64:67], s79 offen offset:2048 sc1
    v_pk_mul_f32 v[52:53], v[104:105], v[150:151]
    v_pk_mul_f32 v[54:55], v[106:107], v[150:151]
    v_pk_mul_f32 v[56:57], v[108:109], v[150:151]
    v_pk_mul_f32 v[58:59], v[110:111], v[150:151]
    v_exp_f32 v52, v52
    v_exp_f32 v53, v53
    v_pk_mul_f32 v[104:105], v[104:105], v[148:149]
    v_exp_f32 v54, v54
    v_exp_f32 v55, v55
    v_pk_mul_f32 v[106:107], v[106:107], v[148:149]
    v_exp_f32 v56, v56
    v_exp_f32 v57, v57
    v_pk_mul_f32 v[108:109], v[108:109], v[148:149]
    v_exp_f32 v58, v58
    v_exp_f32 v59, v59
    v_pk_mul_f32 v[110:111], v[110:111], v[148:149]
    v_pk_add_f32 v[52:53], v[52:53], 1.0 op_sel_hi:[1,0]
    v_pk_add_f32 v[54:55], v[54:55], 1.0 op_sel_hi:[1,0]
    v_pk_add_f32 v[56:57], v[56:57], 1.0 op_sel_hi:[1,0]
    v_pk_add_f32 v[58:59], v[58:59], 1.0 op_sel_hi:[1,0]
    v_rcp_f32 v52, v52
    v_rcp_f32 v53, v53
    v_rcp_f32 v54, v54
    v_rcp_f32 v55, v55
    v_rcp_f32 v56, v56
    v_rcp_f32 v57, v57
    v_rcp_f32 v58, v58
    v_rcp_f32 v59, v59
    v_pk_mul_f32 v[104:105], v[104:105], v[52:53]
    v_pk_mul_f32 v[106:107], v[106:107], v[54:55]
    v_pk_mul_f32 v[108:109], v[108:109], v[56:57]
    v_pk_mul_f32 v[110:111], v[110:111], v[58:59]
    v_cvt_pk_bf16_f32 v104, v104, v105
    v_cvt_pk_bf16_f32 v105, v106, v107
    v_cvt_pk_bf16_f32 v106, v108, v109
    v_cvt_pk_bf16_f32 v107, v110, v111
    buffer_store_dwordx4 v[104:107], v27, s[64:67], s79 offen offset:2304 sc1
    s_and_b32 s77, s6, 3
    s_cmp_eq_u32 s77, 3
    s_cbranch_scc1 NOT2_24
    v_pk_mul_f32 v[44:45], v[112:113], v[146:147]
    v_pk_mul_f32 v[46:47], v[114:115], v[146:147]
    v_pk_mul_f32 v[48:49], v[116:117], v[146:147]
    v_pk_mul_f32 v[50:51], v[118:119], v[146:147]
    v_exp_f32 v44, v44
    v_exp_f32 v45, v45
    v_pk_mul_f32 v[112:113], v[112:113], v[144:145]
    v_exp_f32 v46, v46
    v_exp_f32 v47, v47
    v_pk_mul_f32 v[114:115], v[114:115], v[144:145]
    v_exp_f32 v48, v48
    v_exp_f32 v49, v49
    v_pk_mul_f32 v[116:117], v[116:117], v[144:145]
    v_exp_f32 v50, v50
    v_exp_f32 v51, v51
    v_pk_mul_f32 v[118:119], v[118:119], v[144:145]
    v_pk_add_f32 v[44:45], v[44:45], 1.0 op_sel_hi:[1,0]
    v_pk_add_f32 v[46:47], v[46:47], 1.0 op_sel_hi:[1,0]
    v_pk_add_f32 v[48:49], v[48:49], 1.0 op_sel_hi:[1,0]
    v_pk_add_f32 v[50:51], v[50:51], 1.0 op_sel_hi:[1,0]
    v_rcp_f32 v44, v44
    v_rcp_f32 v45, v45
    v_rcp_f32 v46, v46
    v_rcp_f32 v47, v47
    v_rcp_f32 v48, v48
    v_rcp_f32 v49, v49
    v_rcp_f32 v50, v50
    v_rcp_f32 v51, v51
    v_pk_mul_f32 v[112:113], v[112:113], v[44:45]
    v_pk_mul_f32 v[114:115], v[114:115], v[46:47]
    v_pk_mul_f32 v[116:117], v[116:117], v[48:49]
    v_pk_mul_f32 v[118:119], v[118:119], v[50:51]
    v_cvt_pk_bf16_f32 v112, v112, v113
    v_cvt_pk_bf16_f32 v113, v114, v115
    v_cvt_pk_bf16_f32 v114, v116, v117
    v_cvt_pk_bf16_f32 v115, v118, v119
    buffer_store_dwordx4 v[112:115], v27, s[64:67], s32 offen offset:0 sc1
    v_pk_mul_f32 v[52:53], v[120:121], v[150:151]
    v_pk_mul_f32 v[54:55], v[122:123], v[150:151]
    v_pk_mul_f32 v[56:57], v[124:125], v[150:151]
    v_pk_mul_f32 v[58:59], v[126:127], v[150:151]
    v_exp_f32 v52, v52
    v_exp_f32 v53, v53
    v_pk_mul_f32 v[120:121], v[120:121], v[148:149]
    v_exp_f32 v54, v54
    v_exp_f32 v55, v55
    v_pk_mul_f32 v[122:123], v[122:123], v[148:149]
    v_exp_f32 v56, v56
    v_exp_f32 v57, v57
    v_pk_mul_f32 v[124:125], v[124:125], v[148:149]
    v_exp_f32 v58, v58
    v_exp_f32 v59, v59
    v_pk_mul_f32 v[126:127], v[126:127], v[148:149]
    v_pk_add_f32 v[52:53], v[52:53], 1.0 op_sel_hi:[1,0]
    v_pk_add_f32 v[54:55], v[54:55], 1.0 op_sel_hi:[1,0]
    v_pk_add_f32 v[56:57], v[56:57], 1.0 op_sel_hi:[1,0]
    v_pk_add_f32 v[58:59], v[58:59], 1.0 op_sel_hi:[1,0]
    v_rcp_f32 v52, v52
    v_rcp_f32 v53, v53
    v_rcp_f32 v54, v54
    v_rcp_f32 v55, v55
    v_rcp_f32 v56, v56
    v_rcp_f32 v57, v57
    v_rcp_f32 v58, v58
    v_rcp_f32 v59, v59
    v_pk_mul_f32 v[120:121], v[120:121], v[52:53]
    v_pk_mul_f32 v[122:123], v[122:123], v[54:55]
    v_pk_mul_f32 v[124:125], v[124:125], v[56:57]
    v_pk_mul_f32 v[126:127], v[126:127], v[58:59]
    v_cvt_pk_bf16_f32 v120, v120, v121
    v_cvt_pk_bf16_f32 v121, v122, v123
    v_cvt_pk_bf16_f32 v122, v124, v125
    v_cvt_pk_bf16_f32 v123, v126, v127
    buffer_store_dwordx4 v[120:123], v27, s[64:67], s32 offen offset:256 sc1
NOT2_24:
    s_mul_i32 s75, s4, 360448
    s_lshl_b32 s77, s8, 7
    s_add_u32 s75, s75, s77
    s_mul_i32 s13, s4, 24576
    s_add_u32 s13, s13, 49152
    v_mov_b32 v9, v27
    v_lshrrev_b32 v40, 2, v0
    v_lshlrev_b32 v40, 7, v40
    v_bfe_u32 v41, v0, 3, 2
    v_lshl_add_u32 v40, v41, 5, v40
    v_and_b32 v41, 3, v0
    v_lshl_add_u32 v40, v41, 3, v40
    s_and_b32 s77, s7, 1
    s_lshl_b32 s77, s77, 11
    s_add_u32 s77, s77, s13
    v_add_u32 v16, s77, v40
    v_xor_b32 v17, 32, v16
    v_xor_b32 v18, 64, v16
    v_xor_b32 v19, 96, v16
    v_xor_b32 v5, 2048, v16
    v_xor_b32 v6, 32, v5
    v_xor_b32 v7, 64, v5
    v_xor_b32 v10, 96, v5
    s_and_b32 s77, s4, 2
    s_lshl_b32 s77, s77, 1
    v_add_u32 v42, s77, v20
    s_mul_i32 s73, s7, 327680
    s_mul_i32 s77, s4, 24576
    s_add_u32 s73, s73, s77
    s_mul_i32 s77, s4, 12288
    v_add_u32 v44, s77, v11
    v_add_u32 v45, s13, v11
    v_and_b32 v8, 31, v0
    v_lshlrev_b32 v8, 2, v8
    v_and_b32 v2, 32, v0
    v_lshl_add_u32 v8, v2, 10, v8
    v_and_b32 v4, 15, v0
    v_lshlrev_b32 v4, 4, v4
    v_lshl_add_u32 v4, v2, 3, v4
    v_and_b32 v2, 16, v0
    v_lshl_add_u32 v4, v2, 6, v4
    s_and_b32 s77, s4, 2
    s_add_u32 s77, s77, s4
    s_lshl_b32 s77, s77, 9
    v_add_u32 v4, s77, v4
    v_add_u32 v2, 49152, v4
    v_add_u32 v3, 122880, v4
    s_lshl_b32 s11, s7, 17
    s_lshl_b32 s77, s4, 13
    s_add_u32 s11, s11, s77
    s_lshl_b32 s77, s8, 8
    s_add_u32 s11, s11, s77
    s_waitcnt vmcnt(2)
    ds_add_u32 v20, v21 offset:48
    ds_add_u32 v20, v21 offset:52
    s_lshr_b32 s78, s4, 1
    s_lshl1_add_u32 s77, s5, s78
    s_lshr_b32 s78, s6, 2
    s_lshl2_add_u32 s77, s77, s78
    s_lshl_b32 s77, s77, 8
    s_and_b32 s78, s4, 1
    s_lshl4_add_u32 s77, s78, s77
    s_and_b32 s78, s6, 3
    s_lshl2_add_u32 s77, s78, s77
    s_add_u32 s77, s77, 0xa40000
    v_mov_b32 v43, s10
    v_lshlrev_b32 v22, 8, v0
    s_waitcnt vmcnt(0)
    s_mov_b64 exec, 1
    buffer_store_dword v43, v22, s[64:67], s77 offen sc1
    s_mov_b64 exec, -1
    s_setprio 0
    s_mov_b32 s76, 0x800000
SPIN_26:
    ds_read_b32 v40, v42 offset:48
    s_waitcnt lgkmcnt(0)
    v_readfirstlane_b32 s80, v40
    s_sub_u32 s76, s76, 1
    s_cbranch_scc1 SPR_28
    s_cmp_eq_u32 s80, 8
    s_cbranch_scc1 SPR_28
    s_sleep 1
    s_branch SPIN_26
SPR_28:
SPD_27:
    ds_read_b64_tr_b16 v[96:97], v16 offset:0
    ds_read_b64_tr_b16 v[98:99], v5 offset:0
    ds_read_b64_tr_b16 v[100:101], v17 offset:0
    ds_read_b64_tr_b16 v[102:103], v6 offset:0
    ds_read_b64_tr_b16 v[104:105], v18 offset:0
    ds_read_b64_tr_b16 v[106:107], v7 offset:0
    ds_read_b64_tr_b16 v[108:109], v19 offset:0
    ds_read_b64_tr_b16 v[110:111], v10 offset:0
    s_waitcnt lgkmcnt(4)
    ds_read_b64_tr_b16 v[112:113], v16 offset:4096
    ds_read_b64_tr_b16 v[114:115], v5 offset:4096
    ds_read_b64_tr_b16 v[116:117], v17 offset:4096
    ds_read_b64_tr_b16 v[118:119], v6 offset:4096
    ds_read_b64_tr_b16 v[120:121], v18 offset:4096
    ds_read_b64_tr_b16 v[122:123], v7 offset:4096
    ds_read_b64_tr_b16 v[124:125], v19 offset:4096
    ds_read_b64_tr_b16 v[126:127], v10 offset:4096
    s_waitcnt lgkmcnt(4)
    ds_read_b64_tr_b16 v[128:129], v16 offset:8192
    ds_read_b64_tr_b16 v[130:131], v5 offset:8192
    ds_read_b64_tr_b16 v[132:133], v17 offset:8192
    ds_read_b64_tr_b16 v[134:135], v6 offset:8192
    ds_read_b64_tr_b16 v[136:137], v18 offset:8192
    ds_read_b64_tr_b16 v[138:139], v7 offset:8192
    ds_read_b64_tr_b16 v[140:141], v19 offset:8192
    ds_read_b64_tr_b16 v[142:143], v10 offset:8192
    s_waitcnt lgkmcnt(4)
    ds_read_b64_tr_b16 v[144:145], v16 offset:12288
    ds_read_b64_tr_b16 v[146:147], v5 offset:12288
    ds_read_b64_tr_b16 v[148:149], v17 offset:12288
    ds_read_b64_tr_b16 v[150:151], v6 offset:12288
    ds_read_b64_tr_b16 v[152:153], v18 offset:12288
    ds_read_b64_tr_b16 v[154:155], v7 offset:12288
    ds_read_b64_tr_b16 v[156:157], v19 offset:12288
    ds_read_b64_tr_b16 v[158:159], v10 offset:12288
    s_waitcnt lgkmcnt(4)
    ds_read_b64_tr_b16 v[160:161], v16 offset:16384
    ds_read_b64_tr_b16 v[162:163], v5 offset:16384
    ds_read_b64_tr_b16 v[164:165], v17 offset:16384
    ds_read_b64_tr_b16 v[166:167], v6 offset:16384
    ds_read_b64_tr_b16 v[168:169], v18 offset:16384
    ds_read_b64_tr_b16 v[170:171], v7 offset:16384
    ds_read_b64_tr_b16 v[172:173], v19 offset:16384
    ds_read_b64_tr_b16 v[174:175], v10 offset:16384
    s_waitcnt lgkmcnt(4)
    s_waitcnt lgkmcnt(0)
    s_add_u32 m0, s13, 0
    s_add_u32 s78, s75, 196608
    buffer_load_dwordx4 v14, s[60:63], s78 offen offset:0 lds
    buffer_load_dwordx4 v15, s[60:63], s78 offen offset:1024 lds
    buffer_load_dwordx4 v23, s[60:63], s78 offen offset:2048 lds
    buffer_load_dwordx4 v24, s[60:63], s78 offen offset:3072 lds
    s_add_u32 m0, s13, 4096
    s_add_u32 s78, s75, 229376
    buffer_load_dwordx4 v14, s[60:63], s78 offen offset:0 lds
    buffer_load_dwordx4 v15, s[60:63], s78 offen offset:1024 lds
    buffer_load_dwordx4 v23, s[60:63], s78 offen offset:2048 lds
    buffer_load_dwordx4 v24, s[60:63], s78 offen offset:3072 lds
    s_add_u32 m0, s13, 8192
    s_add_u32 s78, s75, 262144
    buffer_load_dwordx4 v14, s[60:63], s78 offen offset:0 lds
    buffer_load_dwordx4 v15, s[60:63], s78 offen offset:1024 lds
    buffer_load_dwordx4 v23, s[60:63], s78 offen offset:2048 lds
    buffer_load_dwordx4 v24, s[60:63], s78 offen offset:3072 lds
    s_lshl2_add_u32 s26, s7, s4
    s_lshl_b32 s26, s26, 8
    s_add_u32 s26, s26, 0xa40000
    s_mov_b32 s24, s10
    s_mov_b32 s25, s10
    s_load_dwordx8 s[16:23], s[46:47], s26 glc
    s_add_u32 m0, s13, 12288
    s_add_u32 s78, s75, 294912
    buffer_load_dwordx4 v14, s[60:63], s78 offen offset:0 lds
    buffer_load_dwordx4 v15, s[60:63], s78 offen offset:1024 lds
    buffer_load_dwordx4 v23, s[60:63], s78 offen offset:2048 lds
    buffer_load_dwordx4 v24, s[60:63], s78 offen offset:3072 lds
    s_add_u32 m0, s13, 16384
    s_add_u32 s78, s75, 327680
    buffer_load_dwordx4 v14, s[60:63], s78 offen offset:0 lds
    buffer_load_dwordx4 v15, s[60:63], s78 offen offset:1024 lds
    buffer_load_dwordx4 v23, s[60:63], s78 offen offset:2048 lds
    buffer_load_dwordx4 v24, s[60:63], s78 offen offset:3072 lds
    s_mov_b32 s76, 0x200000
POLL_29:
    s_waitcnt lgkmcnt(0)
    s_xor_b64 s[16:17], s[16:17], s[24:25]
    s_xor_b64 s[18:19], s[18:19], s[24:25]
    s_xor_b64 s[20:21], s[20:21], s[24:25]
    s_xor_b64 s[22:23], s[22:23], s[24:25]
    s_or_b64 s[16:17], s[16:17], s[18:19]
    s_or_b64 s[20:21], s[20:21], s[22:23]
    s_or_b64 s[16:17], s[16:17], s[20:21]
    s_cbranch_scc0 PLD_30
    s_sub_u32 s76, s76, 1
    s_cbranch_scc1 PLD_30
    s_load_dwordx8 s[16:23], s[46:47], s26 glc
    s_branch POLL_29
PLD_30:
    s_setprio 1
    s_add_u32 s77, s73, 65536
    buffer_load_dwordx4 v[48:51], v9, s[64:67], s77 offen offset:0 sc1
    buffer_load_dwordx4 v[52:55], v9, s[64:67], s77 offen offset:256 sc1
    buffer_load_dwordx4 v[56:59], v9, s[64:67], s77 offen offset:2048 sc1
    buffer_load_dwordx4 v[60:63], v9, s[64:67], s77 offen offset:2304 sc1
    s_add_u32 s77, s73, 69632
    buffer_load_dwordx4 v[64:67], v9, s[64:67], s77 offen offset:0 sc1
    buffer_load_dwordx4 v[68:71], v9, s[64:67], s77 offen offset:256 sc1
    buffer_load_dwordx4 v[72:75], v9, s[64:67], s77 offen offset:2048 sc1
    buffer_load_dwordx4 v[76:79], v9, s[64:67], s77 offen offset:2304 sc1
    s_add_u32 s77, s73, 73728
    buffer_load_dwordx4 v[80:83], v9, s[64:67], s77 offen offset:0 sc1
    buffer_load_dwordx4 v[84:87], v9, s[64:67], s77 offen offset:256 sc1
    buffer_load_dwordx4 v[88:91], v9, s[64:67], s77 offen offset:2048 sc1
    s_waitcnt vmcnt(10)
    v_mfma_f32_16x16x32_bf16 v[176:179], v[48:51], v[96:99], 0
    buffer_load_dwordx4 v[92:95], v9, s[64:67], s77 offen offset:2304 sc1
    v_mfma_f32_16x16x32_bf16 v[180:183], v[48:51], v[100:103], 0
    v_mfma_f32_16x16x32_bf16 v[192:195], v[48:51], v[104:107], 0
    v_mfma_f32_16x16x32_bf16 v[196:199], v[48:51], v[108:111], 0
    s_waitcnt vmcnt(10)
    v_mfma_f32_16x16x32_bf16 v[184:187], v[52:55], v[96:99], 0
    s_add_u32 s77, s73, 77824
    buffer_load_dwordx4 v[48:51], v9, s[64:67], s77 offen offset:0 sc1
    v_mfma_f32_16x16x32_bf16 v[188:191], v[52:55], v[100:103], 0
    v_mfma_f32_16x16x32_bf16 v[200:203], v[52:55], v[104:107], 0
    v_mfma_f32_16x16x32_bf16 v[204:207], v[52:55], v[108:111], 0
    s_waitcnt vmcnt(10)
    v_mfma_f32_16x16x32_bf16 v[176:179], v[56:59], v[112:115], v[176:179]
    buffer_load_dwordx4 v[52:55], v9, s[64:67], s77 offen offset:256 sc1
    v_mfma_f32_16x16x32_bf16 v[180:183], v[56:59], v[116:119], v[180:183]
    v_mfma_f32_16x16x32_bf16 v[192:195], v[56:59], v[120:123], v[192:195]
    v_mfma_f32_16x16x32_bf16 v[196:199], v[56:59], v[124:127], v[196:199]
    s_waitcnt vmcnt(10)
    v_mfma_f32_16x16x32_bf16 v[184:187], v[60:63], v[112:115], v[184:187]
    buffer_load_dwordx4 v[56:59], v9, s[64:67], s77 offen offset:2048 sc1
    v_mfma_f32_16x16x32_bf16 v[188:191], v[60:63], v[116:119], v[188:191]
    v_mfma_f32_16x16x32_bf16 v[200:203], v[60:63], v[120:123], v[200:203]
    v_mfma_f32_16x16x32_bf16 v[204:207], v[60:63], v[124:127], v[204:207]
    s_waitcnt vmcnt(10)
    v_mfma_f32_16x16x32_bf16 v[176:179], v[64:67], v[128:131], v[176:179]
    buffer_load_dwordx4 v[60:63], v9, s[64:67], s77 offen offset:2304 sc1
    v_mfma_f32_16x16x32_bf16 v[180:183], v[64:67], v[132:135], v[180:183]
    v_mfma_f32_16x16x32_bf16 v[192:195], v[64:67], v[136:139], v[192:195]
    v_mfma_f32_16x16x32_bf16 v[196:199], v[64:67], v[140:143], v[196:199]
    s_waitcnt vmcnt(10)
    v_mfma_f32_16x16x32_bf16 v[184:187], v[68:71], v[128:131], v[184:187]
    s_add_u32 s77, s73, 81920
    buffer_load_dwordx4 v[64:67], v9, s[64:67], s77 offen offset:0 sc1
    v_mfma_f32_16x16x32_bf16 v[188:191], v[68:71], v[132:135], v[188:191]
    v_mfma_f32_16x16x32_bf16 v[200:203], v[68:71], v[136:139], v[200:203]
    v_mfma_f32_16x16x32_bf16 v[204:207], v[68:71], v[140:143], v[204:207]
    s_waitcnt vmcnt(10)
    v_mfma_f32_16x16x32_bf16 v[176:179], v[72:75], v[144:147], v[176:179]
    buffer_load_dwordx4 v[68:71], v9, s[64:67], s77 offen offset:256 sc1
    v_mfma_f32_16x16x32_bf16 v[180:183], v[72:75], v[148:151], v[180:183]
    v_mfma_f32_16x16x32_bf16 v[192:195], v[72:75], v[152:155], v[192:195]
    v_mfma_f32_16x16x32_bf16 v[196:199], v[72:75], v[156:159], v[196:199]
    s_waitcnt vmcnt(10)
    v_mfma_f32_16x16x32_bf16 v[184:187], v[76:79], v[144:147], v[184:187]
    buffer_load_dwordx4 v[72:75], v9, s[64:67], s77 offen offset:2048 sc1
    v_mfma_f32_16x16x32_bf16 v[188:191], v[76:79], v[148:151], v[188:191]
    v_mfma_f32_16x16x32_bf16 v[200:203], v[76:79], v[152:155], v[200:203]
    v_mfma_f32_16x16x32_bf16 v[204:207], v[76:79], v[156:159], v[204:207]
    s_waitcnt vmcnt(10)
    v_mfma_f32_16x16x32_bf16 v[176:179], v[80:83], v[160:163], v[176:179]
    buffer_load_dwordx4 v[76:79], v9, s[64:67], s77 offen offset:2304 sc1
    v_mfma_f32_16x16x32_bf16 v[180:183], v[80:83], v[164:167], v[180:183]
    ds_read_b64_tr_b16 v[24:25], v16 offset:20480
    ds_read_b64_tr_b16 v[26:27], v5 offset:20480
    v_mfma_f32_16x16x32_bf16 v[192:195], v[80:83], v[168:171], v[192:195]
    ds_read_b64_tr_b16 v[28:29], v17 offset:20480
    v_mfma_f32_16x16x32_bf16 v[196:199], v[80:83], v[172:175], v[196:199]
    ds_read_b64_tr_b16 v[30:31], v6 offset:20480
    s_waitcnt vmcnt(10)
    v_mfma_f32_16x16x32_bf16 v[184:187], v[84:87], v[160:163], v[184:187]
    s_add_u32 s77, s73, 86016
    s_cmp_eq_u32 s4, 3
    s_cselect_b32 s77, 0x40000000, s77
    buffer_load_dwordx4 v[80:83], v9, s[64:67], s77 offen offset:0 sc1
    v_mfma_f32_16x16x32_bf16 v[188:191], v[84:87], v[164:167], v[188:191]
    ds_read_b64_tr_b16 v[32:33], v18 offset:20480
    ds_read_b64_tr_b16 v[34:35], v7 offset:20480
    v_mfma_f32_16x16x32_bf16 v[200:203], v[84:87], v[168:171], v[200:203]
    ds_read_b64_tr_b16 v[36:37], v19 offset:20480
    v_mfma_f32_16x16x32_bf16 v[204:207], v[84:87], v[172:175], v[204:207]
    ds_read_b64_tr_b16 v[38:39], v10 offset:20480
    s_waitcnt vmcnt(10) lgkmcnt(4)
    v_mfma_f32_16x16x32_bf16 v[176:179], v[88:91], v[24:27], v[176:179]
    buffer_load_dwordx4 v[84:87], v9, s[64:67], s77 offen offset:256 sc1
    v_mfma_f32_16x16x32_bf16 v[180:183], v[88:91], v[28:31], v[180:183]
    ds_read_b64_tr_b16 v[240:241], v16 offset:0
    ds_read_b64_tr_b16 v[242:243], v5 offset:0
    s_waitcnt lgkmcnt(2)
    v_mfma_f32_16x16x32_bf16 v[192:195], v[88:91], v[32:35], v[192:195]
    ds_read_b64_tr_b16 v[244:245], v17 offset:0
    v_mfma_f32_16x16x32_bf16 v[196:199], v[88:91], v[36:39], v[196:199]
    ds_read_b64_tr_b16 v[246:247], v6 offset:0
    s_waitcnt vmcnt(10)
    v_mfma_f32_16x16x32_bf16 v[184:187], v[92:95], v[24:27], v[184:187]
    s_add_u32 s77, s73, 229376
    buffer_load_dwordx4 v[88:91], v9, s[64:67], s77 offen offset:0 sc1
    v_mfma_f32_16x16x32_bf16 v[188:191], v[92:95], v[28:31], v[188:191]
    ds_read_b64_tr_b16 v[248:249], v18 offset:0
    ds_read_b64_tr_b16 v[250:251], v7 offset:0
    v_mfma_f32_16x16x32_bf16 v[200:203], v[92:95], v[32:35], v[200:203]
    ds_read_b64_tr_b16 v[252:253], v19 offset:0
    v_mfma_f32_16x16x32_bf16 v[204:207], v[92:95], v[36:39], v[204:207]
    ds_read_b64_tr_b16 v[254:255], v10 offset:0
    s_waitcnt vmcnt(10) lgkmcnt(4)
    v_mfma_f32_16x16x32_bf16 v[176:179], v[48:51], v[240:243], v[176:179]
    buffer_load_dwordx4 v[92:95], v9, s[64:67], s77 offen offset:256 sc1
    v_mfma_f32_16x16x32_bf16 v[180:183], v[48:51], v[244:247], v[180:183]
    ds_read_b64_tr_b16 v[24:25], v16 offset:4096
    ds_read_b64_tr_b16 v[26:27], v5 offset:4096
    s_waitcnt lgkmcnt(2)
    v_mfma_f32_16x16x32_bf16 v[192:195], v[48:51], v[248:251], v[192:195]
    ds_read_b64_tr_b16 v[28:29], v17 offset:4096
    v_mfma_f32_16x16x32_bf16 v[196:199], v[48:51], v[252:255], v[196:199]
    ds_read_b64_tr_b16 v[30:31], v6 offset:4096
    s_waitcnt vmcnt(10)
    v_mfma_f32_16x16x32_bf16 v[184:187], v[52:55], v[240:243], v[184:187]
    buffer_load_dwordx4 v[48:51], v9, s[64:67], s77 offen offset:2048 sc1
    v_mfma_f32_16x16x32_bf16 v[188:191], v[52:55], v[244:247], v[188:191]
    ds_read_b64_tr_b16 v[32:33], v18 offset:4096
    ds_read_b64_tr_b16 v[34:35], v7 offset:4096
    v_mfma_f32_16x16x32_bf16 v[200:203], v[52:55], v[248:251], v[200:203]
    ds_read_b64_tr_b16 v[36:37], v19 offset:4096
    v_mfma_f32_16x16x32_bf16 v[204:207], v[52:55], v[252:255], v[204:207]
    ds_read_b64_tr_b16 v[38:39], v10 offset:4096
    s_waitcnt vmcnt(10) lgkmcnt(4)
    v_mfma_f32_16x16x32_bf16 v[176:179], v[56:59], v[24:27], v[176:179]
    buffer_load_dwordx4 v[52:55], v9, s[64:67], s77 offen offset:2304 sc1
    v_mfma_f32_16x16x32_bf16 v[180:183], v[56:59], v[28:31], v[180:183]
    ds_read_b64_tr_b16 v[240:241], v16 offset:8192
    ds_read_b64_tr_b16 v[242:243], v5 offset:8192
    s_waitcnt lgkmcnt(2)
    v_mfma_f32_16x16x32_bf16 v[192:195], v[56:59], v[32:35], v[192:195]
    ds_read_b64_tr_b16 v[244:245], v17 offset:8192
    v_mfma_f32_16x16x32_bf16 v[196:199], v[56:59], v[36:39], v[196:199]
    ds_read_b64_tr_b16 v[246:247], v6 offset:8192
    s_waitcnt vmcnt(10)
    v_mfma_f32_16x16x32_bf16 v[184:187], v[60:63], v[24:27], v[184:187]
    s_add_u32 s77, s73, 233472
    buffer_load_dwordx4 v[56:59], v9, s[64:67], s77 offen offset:0 sc1
    v_mfma_f32_16x16x32_bf16 v[188:191], v[60:63], v[28:31], v[188:191]
    ds_read_b64_tr_b16 v[248:249], v18 offset:8192
    ds_read_b64_tr_b16 v[250:251], v7 offset:8192
    v_mfma_f32_16x16x32_bf16 v[200:203], v[60:63], v[32:35], v[200:203]
    ds_read_b64_tr_b16 v[252:253], v19 offset:8192
    v_mfma_f32_16x16x32_bf16 v[204:207], v[60:63], v[36:39], v[204:207]
    ds_read_b64_tr_b16 v[254:255], v10 offset:8192
    s_waitcnt vmcnt(10) lgkmcnt(4)
    v_mfma_f32_16x16x32_bf16 v[176:179], v[64:67], v[240:243], v[176:179]
    buffer_load_dwordx4 v[60:63], v9, s[64:67], s77 offen offset:256 sc1
    v_mfma_f32_16x16x32_bf16 v[180:183], v[64:67], v[244:247], v[180:183]
    ds_read_b64_tr_b16 v[24:25], v16 offset:12288
    ds_read_b64_tr_b16 v[26:27], v5 offset:12288
    s_waitcnt lgkmcnt(2)
    v_mfma_f32_16x16x32_bf16 v[192:195], v[64:67], v[248:251], v[192:195]
    ds_read_b64_tr_b16 v[28:29], v17 offset:12288
    v_mfma_f32_16x16x32_bf16 v[196:199], v[64:67], v[252:255], v[196:199]
    ds_read_b64_tr_b16 v[30:31], v6 offset:12288
    s_waitcnt vmcnt(10)
    v_mfma_f32_16x16x32_bf16 v[184:187], v[68:71], v[240:243], v[184:187]
    buffer_load_dwordx4 v[64:67], v9, s[64:67], s77 offen offset:2048 sc1
    v_mfma_f32_16x16x32_bf16 v[188:191], v[68:71], v[244:247], v[188:191]
    ds_read_b64_tr_b16 v[32:33], v18 offset:12288
    ds_read_b64_tr_b16 v[34:35], v7 offset:12288
    v_mfma_f32_16x16x32_bf16 v[200:203], v[68:71], v[248:251], v[200:203]
    ds_read_b64_tr_b16 v[36:37], v19 offset:12288
    v_mfma_f32_16x16x32_bf16 v[204:207], v[68:71], v[252:255], v[204:207]
    ds_read_b64_tr_b16 v[38:39], v10 offset:12288
    s_waitcnt vmcnt(10) lgkmcnt(4)
    v_mfma_f32_16x16x32_bf16 v[176:179], v[72:75], v[24:27], v[176:179]
    buffer_load_dwordx4 v[68:71], v9, s[64:67], s77 offen offset:2304 sc1
    v_mfma_f32_16x16x32_bf16 v[180:183], v[72:75], v[28:31], v[180:183]
    ds_read_b64_tr_b16 v[240:241], v16 offset:16384
    ds_read_b64_tr_b16 v[242:243], v5 offset:16384
    s_waitcnt lgkmcnt(2)
    v_mfma_f32_16x16x32_bf16 v[192:195], v[72:75], v[32:35], v[192:195]
    ds_read_b64_tr_b16 v[244:245], v17 offset:16384
    v_mfma_f32_16x16x32_bf16 v[196:199], v[72:75], v[36:39], v[196:199]
    ds_read_b64_tr_b16 v[246:247], v6 offset:16384
    s_waitcnt vmcnt(10)
    v_mfma_f32_16x16x32_bf16 v[184:187], v[76:79], v[24:27], v[184:187]
    s_add_u32 s77, s73, 237568
    buffer_load_dwordx4 v[72:75], v9, s[64:67], s77 offen offset:0 sc1
    v_mfma_f32_16x16x32_bf16 v[188:191], v[76:79], v[28:31], v[188:191]
    ds_read_b64_tr_b16 v[248:249], v18 offset:16384
    ds_read_b64_tr_b16 v[250:251], v7 offset:16384
    v_mfma_f32_16x16x32_bf16 v[200:203], v[76:79], v[32:35], v[200:203]
    ds_read_b64_tr_b16 v[252:253], v19 offset:16384
    v_mfma_f32_16x16x32_bf16 v[204:207], v[76:79], v[36:39], v[204:207]
    ds_read_b64_tr_b16 v[254:255], v10 offset:16384
    s_waitcnt vmcnt(10) lgkmcnt(4)
    v_mfma_f32_16x16x32_bf16 v[176:179], v[80:83], v[240:243], v[176:179]
    buffer_load_dwordx4 v[76:79], v9, s[64:67], s77 offen offset:256 sc1
    v_mfma_f32_16x16x32_bf16 v[180:183], v[80:83], v[244:247], v[180:183]
    s_waitcnt lgkmcnt(0)
    v_mfma_f32_16x16x32_bf16 v[192:195], v[80:83], v[248:251], v[192:195]
    v_mfma_f32_16x16x32_bf16 v[196:199], v[80:83], v[252:255], v[196:199]
    s_waitcnt vmcnt(10)
    v_mfma_f32_16x16x32_bf16 v[184:187], v[84:87], v[240:243], v[184:187]
    buffer_load_dwordx4 v[80:83], v9, s[64:67], s77 offen offset:2048 sc1
    v_mfma_f32_16x16x32_bf16 v[188:191], v[84:87], v[244:247], v[188:191]
    v_mfma_f32_16x16x32_bf16 v[200:203], v[84:87], v[248:251], v[200:203]
    v_mfma_f32_16x16x32_bf16 v[204:207], v[84:87], v[252:255], v[204:207]
    s_waitcnt vmcnt(10)
    v_mfma_f32_16x16x32_bf16 v[208:211], v[88:91], v[96:99], 0
    buffer_load_dwordx4 v[84:87], v9, s[64:67], s77 offen offset:2304 sc1
    v_mfma_f32_16x16x32_bf16 v[212:215], v[88:91], v[100:103], 0
    v_mfma_f32_16x16x32_bf16 v[224:227], v[88:91], v[104:107], 0
    v_mfma_f32_16x16x32_bf16 v[228:231], v[88:91], v[108:111], 0
    s_waitcnt vmcnt(10)
    v_mfma_f32_16x16x32_bf16 v[216:219], v[92:95], v[96:99], 0
    s_add_u32 s77, s73, 241664
    buffer_load_dwordx4 v[88:91], v9, s[64:67], s77 offen offset:0 sc1
    v_mfma_f32_16x16x32_bf16 v[220:223], v[92:95], v[100:103], 0
    v_mfma_f32_16x16x32_bf16 v[232:235], v[92:95], v[104:107], 0
    v_mfma_f32_16x16x32_bf16 v[236:239], v[92:95], v[108:111], 0
    s_mov_b32 s76, 0x800000
SPIN_31:
    ds_read_b32 v46, v20 offset:36
    s_waitcnt lgkmcnt(0)
    v_readfirstlane_b32 s80, v46
    s_sub_u32 s76, s76, 1
    s_cbranch_scc1 SPR_33
    s_cmp_eq_u32 s80, 4
    s_cbranch_scc1 SPR_33
    s_sleep 1
    s_branch SPIN_31
SPR_33:
SPD_32:
    s_waitcnt vmcnt(10)
    v_mfma_f32_16x16x32_bf16 v[208:211], v[48:51], v[112:115], v[208:211]
    buffer_load_dwordx4 v[92:95], v9, s[64:67], s77 offen offset:256 sc1
    v_mfma_f32_16x16x32_bf16 v[212:215], v[48:51], v[116:119], v[212:215]
    ds_write_b128 v44, v[176:179] offset:4096
    v_mfma_f32_16x16x32_bf16 v[224:227], v[48:51], v[120:123], v[224:227]
    ds_write_b128 v44, v[180:183] offset:5120
    v_mfma_f32_16x16x32_bf16 v[228:231], v[48:51], v[124:127], v[228:231]
    s_waitcnt vmcnt(10)
    v_mfma_f32_16x16x32_bf16 v[216:219], v[52:55], v[112:115], v[216:219]
    buffer_load_dwordx4 v[48:51], v9, s[64:67], s77 offen offset:2048 sc1
    v_mfma_f32_16x16x32_bf16 v[220:223], v[52:55], v[116:119], v[220:223]
    ds_write_b128 v44, v[184:187] offset:6144
    v_mfma_f32_16x16x32_bf16 v[232:235], v[52:55], v[120:123], v[232:235]
    ds_write_b128 v44, v[188:191] offset:7168
    v_mfma_f32_16x16x32_bf16 v[236:239], v[52:55], v[124:127], v[236:239]
    s_waitcnt vmcnt(10)
    v_mfma_f32_16x16x32_bf16 v[208:211], v[56:59], v[128:131], v[208:211]
    buffer_load_dwordx4 v[52:55], v9, s[64:67], s77 offen offset:2304 sc1
    v_mfma_f32_16x16x32_bf16 v[212:215], v[56:59], v[132:135], v[212:215]
    ds_write_b128 v44, v[192:195] offset:8192
    v_mfma_f32_16x16x32_bf16 v[224:227], v[56:59], v[136:139], v[224:227]
    ds_write_b128 v44, v[196:199] offset:9216
    v_mfma_f32_16x16x32_bf16 v[228:231], v[56:59], v[140:143], v[228:231]
    s_waitcnt vmcnt(10)
    v_mfma_f32_16x16x32_bf16 v[216:219], v[60:63], v[128:131], v[216:219]
    s_add_u32 s77, s73, 245760
    buffer_load_dwordx4 v[56:59], v9, s[64:67], s77 offen offset:0 sc1
    v_mfma_f32_16x16x32_bf16 v[220:223], v[60:63], v[132:135], v[220:223]
    ds_write_b128 v44, v[200:203] offset:10240
    v_mfma_f32_16x16x32_bf16 v[232:235], v[60:63], v[136:139], v[232:235]
    ds_write_b128 v44, v[204:207] offset:11264
    v_mfma_f32_16x16x32_bf16 v[236:239], v[60:63], v[140:143], v[236:239]
    ds_add_u32 v20, v21 offset:40
    ds_read_b128 v[40:43], v4 offset:24576
    s_waitcnt vmcnt(10)
    v_mfma_f32_16x16x32_bf16 v[208:211], v[64:67], v[144:147], v[208:211]
    buffer_load_dwordx4 v[60:63], v9, s[64:67], s77 offen offset:256 sc1
    v_mfma_f32_16x16x32_bf16 v[212:215], v[64:67], v[148:151], v[212:215]
    v_mfma_f32_16x16x32_bf16 v[224:227], v[64:67], v[152:155], v[224:227]
    v_mfma_f32_16x16x32_bf16 v[228:231], v[64:67], v[156:159], v[228:231]
    s_waitcnt vmcnt(10)
    v_mfma_f32_16x16x32_bf16 v[216:219], v[68:71], v[144:147], v[216:219]
    buffer_load_dwordx4 v[64:67], v9, s[64:67], s77 offen offset:2048 sc1
    v_mfma_f32_16x16x32_bf16 v[220:223], v[68:71], v[148:151], v[220:223]
    v_mfma_f32_16x16x32_bf16 v[232:235], v[68:71], v[152:155], v[232:235]
    v_mfma_f32_16x16x32_bf16 v[236:239], v[68:71], v[156:159], v[236:239]
    s_waitcnt vmcnt(10)
    v_mfma_f32_16x16x32_bf16 v[208:211], v[72:75], v[160:163], v[208:211]
    buffer_load_dwordx4 v[68:71], v9, s[64:67], s77 offen offset:2304 sc1
    v_mfma_f32_16x16x32_bf16 v[212:215], v[72:75], v[164:167], v[212:215]
    ds_read_b64_tr_b16 v[24:25], v16 offset:20480
    ds_read_b64_tr_b16 v[26:27], v5 offset:20480
    v_mfma_f32_16x16x32_bf16 v[224:227], v[72:75], v[168:171], v[224:227]
    ds_read_b64_tr_b16 v[28:29], v17 offset:20480
    v_mfma_f32_16x16x32_bf16 v[228:231], v[72:75], v[172:175], v[228:231]
    ds_read_b64_tr_b16 v[30:31], v6 offset:20480
    s_waitcnt vmcnt(10)
    v_mfma_f32_16x16x32_bf16 v[216:219], v[76:79], v[160:163], v[216:219]
    s_add_u32 s77, s73, 249856
    s_cmp_eq_u32 s4, 3
    s_cselect_b32 s77, 0x40000000, s77
    buffer_load_dwordx4 v[72:75], v9, s[64:67], s77 offen offset:0 sc1
    v_mfma_f32_16x16x32_bf16 v[220:223], v[76:79], v[164:167], v[220:223]
    ds_read_b64_tr_b16 v[32:33], v18 offset:20480
    ds_read_b64_tr_b16 v[34:35], v7 offset:20480
    v_mfma_f32_16x16x32_bf16 v[232:235], v[76:79], v[168:171], v[232:235]
    ds_read_b64_tr_b16 v[36:37], v19 offset:20480
    v_mfma_f32_16x16x32_bf16 v[236:239], v[76:79], v[172:175], v[236:239]
    ds_read_b64_tr_b16 v[38:39], v10 offset:20480
    s_waitcnt vmcnt(10) lgkmcnt(4)
    v_mfma_f32_16x16x32_bf16 v[208:211], v[80:83], v[24:27], v[208:211]
    buffer_load_dwordx4 v[76:79], v9, s[64:67], s77 offen offset:256 sc1
    v_mfma_f32_16x16x32_bf16 v[212:215], v[80:83], v[28:31], v[212:215]
    ds_read_b64_tr_b16 v[240:241], v16 offset:0
    ds_read_b64_tr_b16 v[242:243], v5 offset:0
    s_waitcnt lgkmcnt(2)
    v_mfma_f32_16x16x32_bf16 v[224:227], v[80:83], v[32:35], v[224:227]
    ds_read_b64_tr_b16 v[244:245], v17 offset:0
    v_mfma_f32_16x16x32_bf16 v[228:231], v[80:83], v[36:39], v[228:231]
    ds_read_b64_tr_b16 v[246:247], v6 offset:0
    s_waitcnt vmcnt(10)
    v_mfma_f32_16x16x32_bf16 v[216:219], v[84:87], v[24:27], v[216:219]
    v_mfma_f32_16x16x32_bf16 v[220:223], v[84:87], v[28:31], v[220:223]
    ds_read_b64_tr_b16 v[248:249], v18 offset:0
    ds_read_b64_tr_b16 v[250:251], v7 offset:0
    v_mfma_f32_16x16x32_bf16 v[232:235], v[84:87], v[32:35], v[232:235]
    ds_read_b64_tr_b16 v[252:253], v19 offset:0
    v_mfma_f32_16x16x32_bf16 v[236:239], v[84:87], v[36:39], v[236:239]
    ds_read_b64_tr_b16 v[254:255], v10 offset:0
    s_waitcnt vmcnt(9) lgkmcnt(4)
    v_mfma_f32_16x16x32_bf16 v[208:211], v[88:91], v[240:243], v[208:211]
    v_mfma_f32_16x16x32_bf16 v[212:215], v[88:91], v[244:247], v[212:215]
    ds_read_b64_tr_b16 v[24:25], v16 offset:4096
    ds_read_b64_tr_b16 v[26:27], v5 offset:4096
    s_waitcnt lgkmcnt(2)
    v_mfma_f32_16x16x32_bf16 v[224:227], v[88:91], v[248:251], v[224:227]
    ds_read_b64_tr_b16 v[28:29], v17 offset:4096
    v_mfma_f32_16x16x32_bf16 v[228:231], v[88:91], v[252:255], v[228:231]
    ds_read_b64_tr_b16 v[30:31], v6 offset:4096
    s_waitcnt vmcnt(8)
    v_mfma_f32_16x16x32_bf16 v[216:219], v[92:95], v[240:243], v[216:219]
    v_mfma_f32_16x16x32_bf16 v[220:223], v[92:95], v[244:247], v[220:223]
    ds_read_b64_tr_b16 v[32:33], v18 offset:4096
    ds_read_b64_tr_b16 v[34:35], v7 offset:4096
    v_mfma_f32_16x16x32_bf16 v[232:235], v[92:95], v[248:251], v[232:235]
    ds_read_b64_tr_b16 v[36:37], v19 offset:4096
    v_mfma_f32_16x16x32_bf16 v[236:239], v[92:95], v[252:255], v[236:239]
    ds_read_b64_tr_b16 v[38:39], v10 offset:4096
    s_waitcnt vmcnt(7) lgkmcnt(4)
    v_mfma_f32_16x16x32_bf16 v[208:211], v[48:51], v[24:27], v[208:211]
    v_mfma_f32_16x16x32_bf16 v[212:215], v[48:51], v[28:31], v[212:215]
    ds_read_b64_tr_b16 v[240:241], v16 offset:8192
    ds_read_b64_tr_b16 v[242:243], v5 offset:8192
    s_waitcnt lgkmcnt(2)
    v_mfma_f32_16x16x32_bf16 v[224:227], v[48:51], v[32:35], v[224:227]
    ds_read_b64_tr_b16 v[244:245], v17 offset:8192
    v_mfma_f32_16x16x32_bf16 v[228:231], v[48:51], v[36:39], v[228:231]
    ds_read_b64_tr_b16 v[246:247], v6 offset:8192
    s_waitcnt vmcnt(6)
    v_mfma_f32_16x16x32_bf16 v[216:219], v[52:55], v[24:27], v[216:219]
    v_mfma_f32_16x16x32_bf16 v[220:223], v[52:55], v[28:31], v[220:223]
    ds_read_b64_tr_b16 v[248:249], v18 offset:8192
    ds_read_b64_tr_b16 v[250:251], v7 offset:8192
    v_mfma_f32_16x16x32_bf16 v[232:235], v[52:55], v[32:35], v[232:235]
    ds_read_b64_tr_b16 v[252:253], v19 offset:8192
    v_mfma_f32_16x16x32_bf16 v[236:239], v[52:55], v[36:39], v[236:239]
    ds_read_b64_tr_b16 v[254:255], v10 offset:8192
    s_waitcnt vmcnt(5) lgkmcnt(4)
    v_mfma_f32_16x16x32_bf16 v[208:211], v[56:59], v[240:243], v[208:211]
    v_mfma_f32_16x16x32_bf16 v[212:215], v[56:59], v[244:247], v[212:215]
    ds_read_b64_tr_b16 v[24:25], v16 offset:12288
    ds_read_b64_tr_b16 v[26:27], v5 offset:12288
    s_waitcnt lgkmcnt(2)
    v_mfma_f32_16x16x32_bf16 v[224:227], v[56:59], v[248:251], v[224:227]
    ds_read_b64_tr_b16 v[28:29], v17 offset:12288
    v_mfma_f32_16x16x32_bf16 v[228:231], v[56:59], v[252:255], v[228:231]
    ds_read_b64_tr_b16 v[30:31], v6 offset:12288
    s_waitcnt vmcnt(4)
    v_mfma_f32_16x16x32_bf16 v[216:219], v[60:63], v[240:243], v[216:219]
    v_mfma_f32_16x16x32_bf16 v[220:223], v[60:63], v[244:247], v[220:223]
    ds_read_b64_tr_b16 v[32:33], v18 offset:12288
    ds_read_b64_tr_b16 v[34:35], v7 offset:12288
    v_mfma_f32_16x16x32_bf16 v[232:235], v[60:63], v[248:251], v[232:235]
    ds_read_b64_tr_b16 v[36:37], v19 offset:12288
    v_mfma_f32_16x16x32_bf16 v[236:239], v[60:63], v[252:255], v[236:239]
    ds_read_b64_tr_b16 v[38:39], v10 offset:12288
    s_waitcnt vmcnt(3) lgkmcnt(4)
    v_mfma_f32_16x16x32_bf16 v[208:211], v[64:67], v[24:27], v[208:211]
    v_mfma_f32_16x16x32_bf16 v[212:215], v[64:67], v[28:31], v[212:215]
    ds_read_b64_tr_b16 v[240:241], v16 offset:16384
    ds_read_b64_tr_b16 v[242:243], v5 offset:16384
    s_waitcnt lgkmcnt(2)
    v_mfma_f32_16x16x32_bf16 v[224:227], v[64:67], v[32:35], v[224:227]
    ds_read_b64_tr_b16 v[244:245], v17 offset:16384
    v_mfma_f32_16x16x32_bf16 v[228:231], v[64:67], v[36:39], v[228:231]
    ds_read_b64_tr_b16 v[246:247], v6 offset:16384
    s_waitcnt vmcnt(2)
    v_mfma_f32_16x16x32_bf16 v[216:219], v[68:71], v[24:27], v[216:219]
    v_mfma_f32_16x16x32_bf16 v[220:223], v[68:71], v[28:31], v[220:223]
    ds_read_b64_tr_b16 v[248:249], v18 offset:16384
    ds_read_b64_tr_b16 v[250:251], v7 offset:16384
    v_mfma_f32_16x16x32_bf16 v[232:235], v[68:71], v[32:35], v[232:235]
    ds_read_b64_tr_b16 v[252:253], v19 offset:16384
    v_mfma_f32_16x16x32_bf16 v[236:239], v[68:71], v[36:39], v[236:239]
    ds_read_b64_tr_b16 v[254:255], v10 offset:16384
    s_waitcnt vmcnt(1) lgkmcnt(4)
    v_mfma_f32_16x16x32_bf16 v[208:211], v[72:75], v[240:243], v[208:211]
    v_mfma_f32_16x16x32_bf16 v[212:215], v[72:75], v[244:247], v[212:215]
    s_waitcnt lgkmcnt(0)
    v_mfma_f32_16x16x32_bf16 v[224:227], v[72:75], v[248:251], v[224:227]
    v_mfma_f32_16x16x32_bf16 v[228:231], v[72:75], v[252:255], v[228:231]
    s_waitcnt vmcnt(0)
    v_mfma_f32_16x16x32_bf16 v[216:219], v[76:79], v[240:243], v[216:219]
    v_mfma_f32_16x16x32_bf16 v[220:223], v[76:79], v[244:247], v[220:223]
    v_mfma_f32_16x16x32_bf16 v[232:235], v[76:79], v[248:251], v[232:235]
    v_mfma_f32_16x16x32_bf16 v[236:239], v[76:79], v[252:255], v[236:239]
    s_add_u32 s77, s11, 65664
    s_add_u32 s78, s77, 4096
    s_nop 1
    ds_write_b128 v45, v[208:211] offset:0
    ds_write_b128 v45, v[212:215] offset:1024
    ds_write_b128 v45, v[224:227] offset:4096
    ds_write_b128 v45, v[228:231] offset:5120
    ds_write_b128 v45, v[216:219] offset:2048
    ds_write_b128 v45, v[220:223] offset:3072
    ds_write_b128 v45, v[232:235] offset:6144
    ds_write_b128 v45, v[236:239] offset:7168
    s_waitcnt lgkmcnt(0)
    s_barrier
    ds_read_b128 v[96:99], v2 offset:4096
    ds_read_b128 v[100:103], v2 offset:28672
    ds_read_b128 v[104:107], v2 offset:53248
    ds_read_b128 v[108:111], v3 offset:4096
    s_waitcnt lgkmcnt(3)
    v_pk_add_f32 v[40:41], v[40:41], v[96:97]
    v_pk_add_f32 v[42:43], v[42:43], v[98:99]
    s_waitcnt lgkmcnt(2)
    v_pk_add_f32 v[40:41], v[40:41], v[100:101]
    v_pk_add_f32 v[42:43], v[42:43], v[102:103]
    s_waitcnt lgkmcnt(0)
    v_pk_add_f32 v[104:105], v[104:105], v[108:109]
    v_pk_add_f32 v[106:107], v[106:107], v[110:111]
    v_pk_add_f32 v[40:41], v[40:41], v[104:105]
    v_pk_add_f32 v[42:43], v[42:43], v[106:107]
    buffer_store_dword v40, v8, s[68:71], s77 offen offset:0 sc1
    buffer_store_dword v41, v8, s[68:71], s77 offen offset:2048 sc1
    buffer_store_dword v42, v8, s[68:71], s78 offen offset:0 sc1
    buffer_store_dword v43, v8, s[68:71], s78 offen offset:2048 sc1
    s_lshl_b32 s77, s7, 5
    s_lshl_b32 s78, s8, 2
    s_add_u32 s77, s77, s78
    s_add_u32 s77, s77, s4
    s_cmp_lg_u32 s77, 992
    s_cbranch_scc1 NOEP_34
    v_mov_b32 v44, s10
    s_mov_b32 s77, 0xa60000
    s_mov_b64 exec, 1
    buffer_store_dword v44, v22, s[64:67], s77 offen sc1
    s_mov_b64 exec, -1
NOEP_34:
    s_endpgm
L_SREST:
    s_and_b32 s7, s2, 7
    s_lshr_b32 s32, s2, 3
    s_and_b32 s32, s32, 3
    s_lshl2_add_u32 s7, s7, s32
    s_mov_b32 s48, s16
    s_mov_b32 s49, s17
    s_mov_b32 s50, 0x200000
    s_mov_b32 s51, 0x20000
    s_lshl_b32 s11, s11, 1
    s_mov_b32 s54, 0x80000
    s_mov_b32 s55, 0x20000
    v_lshlrev_b32 v22, 2, v0
    v_add_u32 v22, 154624, v22
    v_mov_b32 v23, 148992
    v_cmp_eq_u32 vcc, 0, v0
    s_nop 1
    v_cndmask_b32 v22, v22, v23, vcc
    v_mov_b32 v23, 1
    v_mov_b32 v24, 0
    v_lshlrev_b32 v33, 2, v0
    v_add_u32 v33, 148992, v33
    ds_write_b32 v33, v24
    s_mov_b32 s72, 0x3f803f80
    s_mov_b32 s64, s46
    s_mov_b32 s65, s47
    s_mov_b32 s66, 0xc00000
    s_mov_b32 s67, 0x20000
    s_mov_b32 s60, s40
    s_mov_b32 s61, s41
    s_mov_b32 s62, 0x158000
    s_mov_b32 s63, 0x20000
    s_lshr_b32 s14, s4, 1
    s_and_b32 s81, s4, 1
    v_bfe_u32 v34, v0, 4, 1
    v_lshrrev_b32 v35, 5, v0
    v_lshlrev_b32 v166, 3, v35
    v_lshl_or_b32 v34, v34, 2, v35
    v_bfe_u32 v35, v0, 1, 2
    v_xor_b32 v34, v34, v35
    v_lshlrev_b32 v34, 4, v34
    v_and_b32 v35, 7, v0
    v_lshl_or_b32 v34, v35, 7, v34
    v_and_b32 v9, 8, v0
    v_lshl_or_b32 v2, v9, 9, v34
    v_lshl_or_b32 v6, v9, 8, v34
    s_lshl_b32 s77, s14, 13
    v_or_b32 v2, s77, v2
    s_mul_i32 s77, s81, 1088
    s_add_u32 s77, s77, 16384
    v_xor_b32 v6, s77, v6
    v_xor_b32 v3, 32, v2
    v_xor_b32 v4, 64, v2
    v_xor_b32 v5, 96, v2
    v_xor_b32 v7, 32, v6
    v_lshrrev_b32 v25, 4, v0
    v_lshl_or_b32 v8, v9, 2, v35
    v_lshl_or_b32 v8, v25, 3, v8
    s_lshl_b32 s78, s14, 8
    s_add_u32 s77, s78, 147968
    v_lshl_add_u32 v8, v8, 2, s77
    v_and_b32 v34, 3, v0
    v_lshl_or_b32 v34, v25, 2, v34
    v_bfe_u32 v35, v0, 2, 2
    v_lshl_or_b32 v46, v35, 4, v34
    s_add_u32 s77, s78, 147456
    v_lshl_add_u32 v46, v46, 2, s77
    v_lshl_or_b32 v1, v35, 5, v34
    s_lshl1_add_u32 s77, s5, s14
    s_lshl_b32 s77, s77, 10
    s_add_u32 s77, s77, 0xa50000
    v_lshl_add_u32 v1, v1, 3, s77
    s_lshl_b32 s15, s6, 10
    s_add_u32 s15, s15, 0xa58000
    v_and_b32 v9, 15, v0
    s_lshl_b32 s78, s81, 8
    s_add_u32 s77, s78, s15
    v_lshl_add_u32 v27, v9, 3, s77
    v_lshl_add_u32 v9, v9, 4, s78
    v_lshlrev_b32 v42, 12, v25
    v_sub_u32 v42, v9, v42
    s_lshl_b32 s77, s5, 10
    s_sub_u32 s77, s77, 512
    v_add_u32 v42, s77, v42
    s_lshl_b32 s77, s14, 2
    v_add_u32 v25, s77, v25
    v_mov_b32 v186, 0
    v_mov_b32 v187, 0
    v_mov_b32 v190, 0
    v_mov_b32 v191, 0
    v_mov_b32 v194, 0
    v_mov_b32 v195, 0
    v_mov_b32 v198, 0
    v_mov_b32 v199, 0
    v_mov_b32 v202, 0
    v_mov_b32 v203, 0
    v_mov_b32 v160, 0
    v_mov_b32 v161, 0
    v_mov_b32 v162, 0
    v_mov_b32 v163, 0
    v_mov_b32 v164, 0
    s_andn2_b32 s33, s11, 15
    s_add_u32 s33, s33, s11
    s_lshl_b32 s33, s33, 3
    s_add_u32 s33, s33, 0xa50000
    s_andn2_b32 s73, s12, 15
    s_add_u32 s73, s73, s12
    s_lshl_b32 s73, s73, 3
    s_add_u32 s73, s73, s15
    v_lshrrev_b32 v169, 3, v0
    v_and_b32 v168, 7, v0
    v_lshrrev_b32 v170, 4, v0
    v_xor_b32 v168, v168, v170
    v_lshlrev_b32 v168, 4, v168
    v_lshl_or_b32 v36, v169, 10, v168
    v_add_u32 v37, 7168, v36
    v_xor_b32 v37, 64, v37
    v_add_u32 v38, 14336, v36
    v_add_u32 v39, 14336, v37
    s_mul_i32 s13, s4, 12288
    s_lshl_b32 s75, s8, 16
    s_lshl_b32 s78, s4, 8
    s_add_u32 s75, s75, s78
    s_and_b32 s78, s4, 1
    s_lshl_b32 s78, s78, 15
    s_xor_b32 s74, s78, 0x8000
    s_add_u32 s74, s74, s75
    s_add_u32 s75, s75, s78
    s_lshl_b32 s77, s4, 11
    s_add_u32 s77, s77, 155648
    v_and_b32 v168, 15, v0
    v_lshl_add_u32 v40, v168, 7, s77
    v_lshrrev_b32 v169, 4, v0
    v_lshlrev_b32 v169, 1, v169
    v_and_b32 v168, 7, v0
    v_xor_b32 v168, v168, v169
    v_lshl_add_u32 v40, v168, 4, v40
    v_xor_b32 v44, 16, v40
    v_bfe_u32 v168, v0, 2, 2
    v_and_b32 v169, 32, v0
    v_lshl_add_u32 v41, v169, 5, s77
    v_lshl_add_u32 v41, v168, 7, v41
    v_and_b32 v169, 1, v0
    v_bfe_u32 v170, v0, 4, 1
    v_lshl_or_b32 v169, v169, 1, v170
    v_xor_b32 v168, v168, v169
    v_lshl_add_u32 v41, v168, 4, v41
    v_and_b32 v169, 2, v0
    v_lshl_add_u32 v41, v169, 2, v41
    v_xor_b32 v45, 64, v41
    v_lshlrev_b32 v47, 4, v0
    s_lshl1_add_u32 s77, s5, s14
    s_mul_i32 s77, s77, 327680
    s_lshl2_add_u32 s78, s6, s81
    s_lshl_b32 s78, s78, 10
    s_add_u32 s11, s77, s78
    s_add_u32 s82, s11, 163840
    s_mov_b32 s84, 0x07060302
    s_waitcnt vmcnt(0) lgkmcnt(0)
    s_mul_i32 s10, s10, 0x9E3779B1
    s_add_u32 s10, s10, 0x7F4A7C15
    v_dot2c_f32_bf16 v160, s72, v48
    v_dot2c_f32_bf16 v161, s72, v52
    v_dot2c_f32_bf16 v162, v48, v48
    v_dot2c_f32_bf16 v163, v52, v52
    v_dot2c_f32_bf16 v164, s72, v56
    v_dot2c_f32_bf16 v160, s72, v49
    v_dot2c_f32_bf16 v161, s72, v53
    v_dot2c_f32_bf16 v162, v49, v49
    v_dot2c_f32_bf16 v163, v53, v53
    v_dot2c_f32_bf16 v164, s72, v57
    v_dot2c_f32_bf16 v160, s72, v50
    v_dot2c_f32_bf16 v161, s72, v54
    v_dot2c_f32_bf16 v162, v50, v50
    v_dot2c_f32_bf16 v163, v54, v54
    v_dot2c_f32_bf16 v164, s72, v58
    v_dot2c_f32_bf16 v160, s72, v51
    v_dot2c_f32_bf16 v161, s72, v55
    v_dot2c_f32_bf16 v162, v51, v51
    v_dot2c_f32_bf16 v163, v55, v55
    v_dot2c_f32_bf16 v164, s72, v59
    s_setprio 2
    s_barrier
    ds_read_b128 v[64:67], v6 offset:0
    ds_read_b128 v[68:71], v6 offset:4096
    ds_read_b128 v[48:51], v2 offset:0
    ds_read_b128 v[52:55], v4 offset:1024
    ds_read_b128 v[56:59], v2 offset:2048
    ds_read_b128 v[60:63], v4 offset:3072
    ds_read_b128 v[72:75], v3 offset:0
    ds_read_b128 v[76:79], v5 offset:1024
    ds_read_b128 v[80:83], v3 offset:2048
    ds_read_b128 v[84:87], v5 offset:3072
    ds_read_b128 v[88:91], v7 offset:0
    ds_read_b128 v[92:95], v7 offset:4096
    s_waitcnt lgkmcnt(8)
    v_mfma_f32_16x16x32_bf16 v[96:99], v[48:51], v[64:67], 0
    s_nop 2
    v_mov_b32 v165, v164
    v_mfma_f32_16x16x32_bf16 v[112:115], v[48:51], v[68:71], 0
    v_permlane32_swap_b32 v160, v161
    v_permlane32_swap_b32 v162, v163
    v_permlane32_swap_b32 v164, v165
    v_mfma_f32_16x16x32_bf16 v[100:103], v[52:55], v[64:67], 0
    v_add_f32 v160, v160, v161
    v_add_f32 v162, v162, v163
    v_mfma_f32_16x16x32_bf16 v[116:119], v[52:55], v[68:71], 0
    v_add_f32 v164, v164, v165
    v_mov_b32 v161, v160
    v_mov_b32 v163, v162
    s_waitcnt lgkmcnt(6)
    v_mfma_f32_16x16x32_bf16 v[104:107], v[56:59], v[64:67], 0
    v_mov_b32 v165, v164
    v_permlane16_swap_b32 v160, v161
    v_mfma_f32_16x16x32_bf16 v[120:123], v[56:59], v[68:71], 0
    s_nop 0
    v_permlane16_swap_b32 v162, v163
    v_permlane16_swap_b32 v164, v165
    v_mfma_f32_16x16x32_bf16 v[108:111], v[60:63], v[64:67], 0
    v_add_f32 v160, v160, v161
    v_add_f32 v162, v162, v163
    v_mfma_f32_16x16x32_bf16 v[124:127], v[60:63], v[68:71], 0
    v_add_f32 v164, v164, v165
    v_add_f32_dpp v160, v160, v160 quad_perm:[1,0,3,2] row_mask:0xf bank_mask:0xf
    v_add_f32_dpp v162, v162, v162 quad_perm:[1,0,3,2] row_mask:0xf bank_mask:0xf
    s_barrier
    ds_read_b128 v[64:67], v6 offset:24576
    ds_read_b128 v[68:71], v6 offset:28672
    ds_read_b128 v[48:51], v2 offset:24576
    ds_read_b128 v[52:55], v4 offset:25600
    ds_read_b128 v[56:59], v2 offset:26624
    ds_read_b128 v[60:63], v4 offset:27648
    s_lshl_b32 s77, s2, 2
    s_add_u32 s77, s77, s4
    s_lshl_b32 s77, s77, 10
    s_mov_b32 s71, 0x20000
    s_mov_b32 s68, s38
    s_mov_b32 s69, s39
    s_mov_b32 s70, 0x158000
    s_xor_b32 s78, s4, 0
    s_lshl_b32 s78, s78, 8
    s_add_u32 s78, s78, s2
    s_lshl_b32 s78, s78, 10
    s_add_u32 s78, s78, 1048576
    buffer_load_dwordx4 v[176:179], v47, s[68:71], s77 offen
    buffer_load_dwordx4 v[180:183], v47, s[68:71], s78 offen
    s_waitcnt lgkmcnt(6)
    v_mfma_f32_16x16x32_bf16 v[96:99], v[72:75], v[88:91], v[96:99]
    v_add_f32_dpp v164, v164, v164 quad_perm:[1,0,3,2] row_mask:0xf bank_mask:0xf
    v_add_f32_dpp v160, v160, v160 quad_perm:[2,3,0,1] row_mask:0xf bank_mask:0xf
    v_mfma_f32_16x16x32_bf16 v[112:115], v[72:75], v[92:95], v[112:115]
    v_add_f32_dpp v162, v162, v162 quad_perm:[2,3,0,1] row_mask:0xf bank_mask:0xf
    v_add_f32_dpp v164, v164, v164 quad_perm:[2,3,0,1] row_mask:0xf bank_mask:0xf
    v_add_f32_dpp v160, v160, v160 row_half_mirror row_mask:0xf bank_mask:0xf
    ds_read_b128 v[72:75], v3 offset:24576
    v_mfma_f32_16x16x32_bf16 v[100:103], v[76:79], v[88:91], v[100:103]
    v_add_f32_dpp v162, v162, v162 row_half_mirror row_mask:0xf bank_mask:0xf
    v_add_f32_dpp v164, v164, v164 row_half_mirror row_mask:0xf bank_mask:0xf
    v_mfma_f32_16x16x32_bf16 v[116:119], v[76:79], v[92:95], v[116:119]
    v_add_f32_dpp v160, v160, v160 row_mirror row_mask:0xf bank_mask:0xf
    v_add_f32_dpp v162, v162, v162 row_mirror row_mask:0xf bank_mask:0xf
    v_add_f32_dpp v164, v164, v164 row_mirror row_mask:0xf bank_mask:0xf
    ds_read_b128 v[76:79], v5 offset:25600
    v_mfma_f32_16x16x32_bf16 v[104:107], v[80:83], v[88:91], v[104:107]
    v_mul_f32 v160, 0x3b000000, v160
    v_mul_f32 v162, 0x3b000000, v162
    v_mfma_f32_16x16x32_bf16 v[120:123], v[80:83], v[92:95], v[120:123]
    v_fma_f32 v162, -v160, v160, v162
    v_max_f32 v162, 0, v162
    v_cvt_pk_bf16_f32 v162, v162, v162
    ds_read_b128 v[80:83], v3 offset:26624
    v_mfma_f32_16x16x32_bf16 v[108:111], v[84:87], v[88:91], v[108:111]
    v_and_b32 v162, 0xffff0000, v162
    v_add_f32 v162, 0x3727c5ac, v162
    v_mfma_f32_16x16x32_bf16 v[124:127], v[84:87], v[92:95], v[124:127]
    v_cvt_pk_bf16_f32 v162, v162, v162
    v_and_b32 v162, 0xffff0000, v162
    v_sqrt_f32 v162, v162
    ds_read_b128 v[84:87], v5 offset:27648
    ds_read_b128 v[88:91], v7 offset:24576
    ds_read_b128 v[92:95], v7 offset:28672
    s_waitcnt lgkmcnt(8)
    v_mfma_f32_16x16x32_bf16 v[96:99], v[48:51], v[64:67], v[96:99]
    v_mov_b32 v161, s10
    v_mov_b32 v165, s10
    v_mfma_f32_16x16x32_bf16 v[112:115], v[48:51], v[68:71], v[112:115]
    v_cvt_pk_bf16_f32 v160, v160, v162
    s_mov_b32 exec_lo, 1
    s_mov_b32 exec_hi, 1
    buffer_store_dwordx2 v[160:161], v166, s[64:67], s33 offen sc1
    s_mov_b32 exec_hi, 0
    buffer_store_dwordx2 v[164:165], v24, s[64:67], s73 offen sc1
    s_mov_b64 exec, -1
    v_mfma_f32_16x16x32_bf16 v[100:103], v[52:55], v[64:67], v[100:103]
    s_mov_b64 s[52:53], s[26:27]
    s_mov_b64 s[56:57], s[28:29]
    v_mfma_f32_16x16x32_bf16 v[116:119], v[52:55], v[68:71], v[116:119]
    s_mov_b32 s58, 0x80000
    s_mov_b32 s59, 0x20000
    v_lshlrev_b32 v29, 16, v29
    s_waitcnt lgkmcnt(6)
    v_mfma_f32_16x16x32_bf16 v[104:107], v[56:59], v[64:67], v[104:107]
    v_lshlrev_b32 v30, 16, v30
    v_lshlrev_b32 v31, 16, v31
    v_mfma_f32_16x16x32_bf16 v[120:123], v[56:59], v[68:71], v[120:123]
    v_mul_f32 v31, 0x3fb8aa3b, v31
    v_exp_f32 v31, v31
    s_nop 0
    v_mfma_f32_16x16x32_bf16 v[108:111], v[60:63], v[64:67], v[108:111]
    v_cvt_pk_bf16_f32 v31, v31, v31
    v_and_b32 v31, 0xffff0000, v31
    v_mfma_f32_16x16x32_bf16 v[124:127], v[60:63], v[68:71], v[124:127]
    v_mul_f32 v32, v31, v29
    v_mul_f32 v33, v31, v30
    v_mul_f32 v32, 0x3fb8aa3b, v32
    s_barrier
    ds_read_b128 v[64:67], v6 offset:49152
    ds_read_b128 v[68:71], v6 offset:53248
    ds_read_b128 v[48:51], v2 offset:49152
    ds_read_b128 v[52:55], v4 offset:50176
    ds_read_b128 v[56:59], v2 offset:51200
    ds_read_b128 v[60:63], v4 offset:52224
    s_waitcnt lgkmcnt(6)
    v_mfma_f32_16x16x32_bf16 v[96:99], v[72:75], v[88:91], v[96:99]
    v_mul_f32 v33, 0.15915494, v33
    v_rndne_f32 v34, v33
    v_mfma_f32_16x16x32_bf16 v[112:115], v[72:75], v[92:95], v[112:115]
    v_sub_f32 v33, v33, v34
    v_exp_f32 v32, v32
    v_cos_f32 v34, v33
    ds_read_b128 v[72:75], v3 offset:49152
    v_mfma_f32_16x16x32_bf16 v[100:103], v[76:79], v[88:91], v[100:103]
    v_sin_f32 v35, v33
    v_mul_f32 v168, v29, v29
    v_mfma_f32_16x16x32_bf16 v[116:119], v[76:79], v[92:95], v[116:119]
    v_mul_f32 v10, v32, v34
    v_mul_f32 v11, v32, v35
    v_fmac_f32 v168, v30, v30
    ds_read_b128 v[76:79], v5 offset:50176
    v_mfma_f32_16x16x32_bf16 v[104:107], v[80:83], v[88:91], v[104:107]
    v_rcp_f32 v168, v168
    v_add_f32 v32, -1.0, v10
    v_mfma_f32_16x16x32_bf16 v[120:123], v[80:83], v[92:95], v[120:123]
    v_mul_f32 v18, v32, v29
    v_mul_f32 v19, v11, v29
    v_fmac_f32 v18, v11, v30
    ds_read_b128 v[80:83], v3 offset:51200
    v_mfma_f32_16x16x32_bf16 v[108:111], v[84:87], v[88:91], v[108:111]
    v_fma_f32 v19, -v32, v30, v19
    v_add_f32 v168, v168, v168
    v_mfma_f32_16x16x32_bf16 v[124:127], v[84:87], v[92:95], v[124:127]
    v_mul_f32 v18, v18, v168
    v_mul_f32 v19, v19, v168
    v_sub_f32 v26, 0, v11
    ds_read_b128 v[84:87], v5 offset:52224
    ds_read_b128 v[88:91], v7 offset:49152
    ds_read_b128 v[92:95], v7 offset:53248
    s_waitcnt lgkmcnt(8)
    v_mfma_f32_16x16x32_bf16 v[96:99], v[48:51], v[64:67], v[96:99]
    v_mul_f32 v28, v10, v10
    v_mul_f32 v29, v10, v11
    v_mfma_f32_16x16x32_bf16 v[112:115], v[48:51], v[68:71], v[112:115]
    v_fma_f32 v28, -v11, v11, v28
    v_fmac_f32 v29, v11, v10
    v_mul_f32 v30, v28, v28
    v_mfma_f32_16x16x32_bf16 v[100:103], v[52:55], v[64:67], v[100:103]
    v_mul_f32 v31, v28, v29
    v_fma_f32 v30, -v29, v29, v30
    v_mfma_f32_16x16x32_bf16 v[116:119], v[52:55], v[68:71], v[116:119]
    v_fmac_f32 v31, v29, v28
    v_mul_f32 v28, v30, v30
    v_mul_f32 v29, v30, v31
    s_waitcnt lgkmcnt(6)
    v_mfma_f32_16x16x32_bf16 v[104:107], v[56:59], v[64:67], v[104:107]
    v_fma_f32 v28, -v31, v31, v28
    v_fmac_f32 v29, v31, v30
    v_mfma_f32_16x16x32_bf16 v[120:123], v[56:59], v[68:71], v[120:123]
    v_mul_f32 v12, v28, v28
    v_mul_f32 v13, v28, v29
    v_fma_f32 v12, -v29, v29, v12
    v_mfma_f32_16x16x32_bf16 v[108:111], v[60:63], v[64:67], v[108:111]
    v_fmac_f32 v13, v29, v28
    v_mul_f32 v28, v12, v12
    v_mfma_f32_16x16x32_bf16 v[124:127], v[60:63], v[68:71], v[124:127]
    v_mul_f32 v29, v12, v13
    v_fma_f32 v28, -v13, v13, v28
    v_fmac_f32 v29, v13, v12
    v_add_u32 v2, 73728, v2
    v_add_u32 v3, 73728, v3
    v_add_u32 v4, 73728, v4
    v_add_u32 v5, 73728, v5
    v_add_u32 v6, 73728, v6
    v_add_u32 v7, 73728, v7
    s_barrier
    ds_read_b128 v[64:67], v6 offset:0
    ds_read_b128 v[68:71], v6 offset:4096
    ds_read_b128 v[48:51], v2 offset:0
    ds_read_b128 v[52:55], v4 offset:1024
    ds_read_b128 v[56:59], v2 offset:2048
    ds_read_b128 v[60:63], v4 offset:3072
    s_waitcnt lgkmcnt(6)
    v_mfma_f32_16x16x32_bf16 v[96:99], v[72:75], v[88:91], v[96:99]
    v_mul_f32 v30, v28, v28
    v_mul_f32 v31, v28, v29
    v_mfma_f32_16x16x32_bf16 v[112:115], v[72:75], v[92:95], v[112:115]
    v_fma_f32 v30, -v29, v29, v30
    v_fmac_f32 v31, v29, v28
    v_mul_f32 v14, v30, v30
    ds_read_b128 v[72:75], v3 offset:0
    v_mfma_f32_16x16x32_bf16 v[100:103], v[76:79], v[88:91], v[100:103]
    v_mul_f32 v15, v30, v31
    v_fma_f32 v14, -v31, v31, v14
    v_mfma_f32_16x16x32_bf16 v[116:119], v[76:79], v[92:95], v[116:119]
    v_fmac_f32 v15, v31, v30
    v_and_b32 v32, 16, v0
    v_cmp_ne_u32 vcc, 0, v32
    ds_read_b128 v[76:79], v5 offset:1024
    v_mfma_f32_16x16x32_bf16 v[104:107], v[80:83], v[88:91], v[104:107]
    s_nop 1
    v_cndmask_b32 v20, 1.0, v12, vcc
    v_mfma_f32_16x16x32_bf16 v[120:123], v[80:83], v[92:95], v[120:123]
    v_cndmask_b32 v21, 0, v13, vcc
    v_cmp_lt_u32 vcc, 31, v0
    s_nop 1
    ds_read_b128 v[80:83], v3 offset:2048
    v_mfma_f32_16x16x32_bf16 v[108:111], v[84:87], v[88:91], v[108:111]
    v_cndmask_b32 v28, 1.0, v28, vcc
    v_cndmask_b32 v29, 0, v29, vcc
    v_mfma_f32_16x16x32_bf16 v[124:127], v[84:87], v[92:95], v[124:127]
    s_bitcmp1_b32 s4, 1
    s_cselect_b64 vcc, -1, 0
    v_cndmask_b32 v30, 1.0, v30, vcc
    ds_read_b128 v[84:87], v5 offset:3072
    ds_read_b128 v[88:91], v7 offset:0
    ds_read_b128 v[92:95], v7 offset:4096
    s_waitcnt lgkmcnt(8)
    v_mfma_f32_16x16x32_bf16 v[96:99], v[48:51], v[64:67], v[96:99]
    v_cndmask_b32 v31, 0, v31, vcc
    v_mul_f32 v32, v20, v28
    v_mfma_f32_16x16x32_bf16 v[112:115], v[48:51], v[68:71], v[112:115]
    v_mul_f32 v33, v20, v29
    v_fma_f32 v32, -v21, v29, v32
    v_fmac_f32 v33, v21, v28
    v_mfma_f32_16x16x32_bf16 v[100:103], v[52:55], v[64:67], v[100:103]
    v_mul_f32 v20, v32, v30
    v_mul_f32 v21, v32, v31
    v_mfma_f32_16x16x32_bf16 v[116:119], v[52:55], v[68:71], v[116:119]
    v_fma_f32 v20, -v33, v31, v20
    v_fmac_f32 v21, v33, v30
    v_mul_f32 v28, v32, v32
    s_waitcnt lgkmcnt(6)
    v_mfma_f32_16x16x32_bf16 v[104:107], v[56:59], v[64:67], v[104:107]
    v_mul_f32 v29, v32, v33
    v_fma_f32 v28, -v33, v33, v28
    v_mfma_f32_16x16x32_bf16 v[120:123], v[56:59], v[68:71], v[120:123]
    v_fmac_f32 v29, v33, v32
    v_mul_f32 v30, v28, v28
    v_mul_f32 v31, v28, v29
    v_mfma_f32_16x16x32_bf16 v[108:111], v[60:63], v[64:67], v[108:111]
    v_fma_f32 v30, -v29, v29, v30
    v_fmac_f32 v31, v29, v28
    v_mfma_f32_16x16x32_bf16 v[124:127], v[60:63], v[68:71], v[124:127]
    v_mul_f32 v28, v30, v30
    v_mul_f32 v29, v30, v31
    v_fma_f32 v28, -v31, v31, v28
    s_barrier
    ds_read_b128 v[64:67], v6 offset:24576
    ds_read_b128 v[68:71], v6 offset:28672
    ds_read_b128 v[48:51], v2 offset:24576
    ds_read_b128 v[52:55], v4 offset:25600
    ds_read_b128 v[56:59], v2 offset:26624
    ds_read_b128 v[60:63], v4 offset:27648
    s_waitcnt lgkmcnt(6)
    v_mfma_f32_16x16x32_bf16 v[96:99], v[72:75], v[88:91], v[96:99]
    v_fmac_f32 v29, v31, v30
    v_mul_f32 v30, v28, v28
    v_mfma_f32_16x16x32_bf16 v[112:115], v[72:75], v[92:95], v[112:115]
    v_mul_f32 v31, v28, v29
    v_fma_f32 v30, -v29, v29, v30
    v_fmac_f32 v31, v29, v28
    ds_read_b128 v[72:75], v3 offset:24576
    v_mfma_f32_16x16x32_bf16 v[100:103], v[76:79], v[88:91], v[100:103]
    v_mul_f32 v16, v30, v30
    v_mul_f32 v17, v30, v31
    v_mfma_f32_16x16x32_bf16 v[116:119], v[76:79], v[92:95], v[116:119]
    v_fma_f32 v16, -v31, v31, v16
    v_fmac_f32 v17, v31, v30
    ds_read_b128 v[76:79], v5 offset:25600
    v_mfma_f32_16x16x32_bf16 v[104:107], v[80:83], v[88:91], v[104:107]
    v_mfma_f32_16x16x32_bf16 v[120:123], v[80:83], v[92:95], v[120:123]
    ds_read_b128 v[80:83], v3 offset:26624
    v_mfma_f32_16x16x32_bf16 v[108:111], v[84:87], v[88:91], v[108:111]
    v_mfma_f32_16x16x32_bf16 v[124:127], v[84:87], v[92:95], v[124:127]
    ds_read_b128 v[84:87], v5 offset:27648
    ds_read_b128 v[88:91], v7 offset:24576
    ds_read_b128 v[92:95], v7 offset:28672
    s_waitcnt lgkmcnt(8)
    v_mfma_f32_16x16x32_bf16 v[96:99], v[48:51], v[64:67], v[96:99]
    v_mfma_f32_16x16x32_bf16 v[112:115], v[48:51], v[68:71], v[112:115]
    v_mfma_f32_16x16x32_bf16 v[100:103], v[52:55], v[64:67], v[100:103]
    v_mfma_f32_16x16x32_bf16 v[116:119], v[52:55], v[68:71], v[116:119]
    s_waitcnt lgkmcnt(6)
    v_mfma_f32_16x16x32_bf16 v[104:107], v[56:59], v[64:67], v[104:107]
    v_mfma_f32_16x16x32_bf16 v[120:123], v[56:59], v[68:71], v[120:123]
    v_mfma_f32_16x16x32_bf16 v[108:111], v[60:63], v[64:67], v[108:111]
    v_mfma_f32_16x16x32_bf16 v[124:127], v[60:63], v[68:71], v[124:127]
    s_barrier
    ds_read_b128 v[64:67], v6 offset:49152
    ds_read_b128 v[68:71], v6 offset:53248
    ds_read_b128 v[48:51], v2 offset:49152
    ds_read_b128 v[52:55], v4 offset:50176
    ds_read_b128 v[56:59], v2 offset:51200
    ds_read_b128 v[60:63], v4 offset:52224
    buffer_load_dwordx2 v[128:129], v1, s[64:67], 0 offen sc1
    buffer_load_dwordx2 v[130:131], v27, s[64:67], 0 offen sc1
    buffer_load_dwordx2 v[132:133], v27, s[64:67], 0 offen offset:512 sc1
    s_waitcnt lgkmcnt(6)
    v_mfma_f32_16x16x32_bf16 v[96:99], v[72:75], v[88:91], v[96:99]
    v_mfma_f32_16x16x32_bf16 v[112:115], v[72:75], v[92:95], v[112:115]
    ds_read_b128 v[72:75], v3 offset:49152
    v_mfma_f32_16x16x32_bf16 v[100:103], v[76:79], v[88:91], v[100:103]
    v_mfma_f32_16x16x32_bf16 v[116:119], v[76:79], v[92:95], v[116:119]
    ds_read_b128 v[76:79], v5 offset:50176
    v_mfma_f32_16x16x32_bf16 v[104:107], v[80:83], v[88:91], v[104:107]
    v_mfma_f32_16x16x32_bf16 v[120:123], v[80:83], v[92:95], v[120:123]
    ds_read_b128 v[80:83], v3 offset:51200
    v_mfma_f32_16x16x32_bf16 v[108:111], v[84:87], v[88:91], v[108:111]
    v_mfma_f32_16x16x32_bf16 v[124:127], v[84:87], v[92:95], v[124:127]
    ds_read_b128 v[84:87], v5 offset:52224
    ds_read_b128 v[88:91], v7 offset:49152
    ds_read_b128 v[92:95], v7 offset:53248
    s_waitcnt lgkmcnt(8)
    v_mfma_f32_16x16x32_bf16 v[96:99], v[48:51], v[64:67], v[96:99]
    v_mfma_f32_16x16x32_bf16 v[112:115], v[48:51], v[68:71], v[112:115]
    v_mfma_f32_16x16x32_bf16 v[100:103], v[52:55], v[64:67], v[100:103]
    v_mfma_f32_16x16x32_bf16 v[116:119], v[52:55], v[68:71], v[116:119]
    s_waitcnt lgkmcnt(6)
    v_mfma_f32_16x16x32_bf16 v[104:107], v[56:59], v[64:67], v[104:107]
    v_mfma_f32_16x16x32_bf16 v[120:123], v[56:59], v[68:71], v[120:123]
    v_mfma_f32_16x16x32_bf16 v[108:111], v[60:63], v[64:67], v[108:111]
    v_mfma_f32_16x16x32_bf16 v[124:127], v[60:63], v[68:71], v[124:127]
    v_subrev_u32 v2, 73728, v2
    v_subrev_u32 v3, 73728, v3
    v_subrev_u32 v4, 73728, v4
    v_subrev_u32 v5, 73728, v5
    v_subrev_u32 v6, 73728, v6
    v_subrev_u32 v7, 73728, v7
    s_barrier
    ds_read_b128 v[64:67], v6 offset:0
    ds_read_b128 v[68:71], v6 offset:4096
    ds_read_b128 v[48:51], v2 offset:0
    ds_read_b128 v[52:55], v4 offset:1024
    ds_read_b128 v[56:59], v2 offset:2048
    ds_read_b128 v[60:63], v4 offset:3072
    s_waitcnt lgkmcnt(6)
    v_mfma_f32_16x16x32_bf16 v[96:99], v[72:75], v[88:91], v[96:99]
    v_mfma_f32_16x16x32_bf16 v[112:115], v[72:75], v[92:95], v[112:115]
    ds_read_b128 v[72:75], v3 offset:0
    v_mfma_f32_16x16x32_bf16 v[100:103], v[76:79], v[88:91], v[100:103]
    v_mfma_f32_16x16x32_bf16 v[116:119], v[76:79], v[92:95], v[116:119]
    ds_read_b128 v[76:79], v5 offset:1024
    v_mfma_f32_16x16x32_bf16 v[104:107], v[80:83], v[88:91], v[104:107]
    v_mfma_f32_16x16x32_bf16 v[120:123], v[80:83], v[92:95], v[120:123]
    ds_read_b128 v[80:83], v3 offset:2048
    v_mfma_f32_16x16x32_bf16 v[108:111], v[84:87], v[88:91], v[108:111]
    v_mfma_f32_16x16x32_bf16 v[124:127], v[84:87], v[92:95], v[124:127]
    ds_read_b128 v[84:87], v5 offset:3072
    ds_read_b128 v[88:91], v7 offset:0
    ds_read_b128 v[92:95], v7 offset:4096
    s_waitcnt lgkmcnt(8)
    v_mfma_f32_16x16x32_bf16 v[96:99], v[48:51], v[64:67], v[96:99]
    v_mfma_f32_16x16x32_bf16 v[112:115], v[48:51], v[68:71], v[112:115]
    v_mfma_f32_16x16x32_bf16 v[100:103], v[52:55], v[64:67], v[100:103]
    v_mfma_f32_16x16x32_bf16 v[116:119], v[52:55], v[68:71], v[116:119]
    s_waitcnt lgkmcnt(6)
    v_mfma_f32_16x16x32_bf16 v[104:107], v[56:59], v[64:67], v[104:107]
    v_mfma_f32_16x16x32_bf16 v[120:123], v[56:59], v[68:71], v[120:123]
    v_mfma_f32_16x16x32_bf16 v[108:111], v[60:63], v[64:67], v[108:111]
    v_mfma_f32_16x16x32_bf16 v[124:127], v[60:63], v[68:71], v[124:127]
    s_barrier
    ds_read_b128 v[64:67], v6 offset:24576
    ds_read_b128 v[68:71], v6 offset:28672
    ds_read_b128 v[48:51], v2 offset:24576
    ds_read_b128 v[52:55], v4 offset:25600
    ds_read_b128 v[56:59], v2 offset:26624
    ds_read_b128 v[60:63], v4 offset:27648
    s_mov_b32 s76, 0x200000
    s_waitcnt vmcnt(0)
RC_36:
    v_cmp_ne_u32 vcc, s10, v129
    v_cmp_ne_u32 s[100:101], s10, v131
    s_or_b64 vcc, vcc, s[100:101]
    v_cmp_ne_u32 s[100:101], s10, v133
    s_or_b64 vcc, vcc, s[100:101]
    s_cmp_eq_u64 vcc, 0
    s_cbranch_scc1 RCD_37
    s_sub_u32 s76, s76, 1
    s_cbranch_scc1 RCD_37
    s_sleep 2
    buffer_load_dwordx2 v[128:129], v1, s[64:67], 0 offen sc1
    buffer_load_dwordx2 v[130:131], v27, s[64:67], 0 offen sc1
    buffer_load_dwordx2 v[132:133], v27, s[64:67], 0 offen offset:512 sc1
    s_waitcnt vmcnt(0)
    s_branch RC_36
RCD_37:
    s_waitcnt lgkmcnt(6)
    v_mfma_f32_16x16x32_bf16 v[96:99], v[72:75], v[88:91], v[96:99]
    v_and_b32 v29, 0xffff0000, v128
    v_rcp_f32 v29, v29
    v_mfma_f32_16x16x32_bf16 v[112:115], v[72:75], v[92:95], v[112:115]
    v_lshlrev_b32 v30, 16, v128
    v_cvt_pk_bf16_f32 v30, -v30, -v30
    v_lshlrev_b32 v31, 6, v25
    ds_read_b128 v[72:75], v3 offset:24576
    v_mfma_f32_16x16x32_bf16 v[100:103], v[76:79], v[88:91], v[100:103]
    v_add_u32 v31, 147456, v31
    s_mov_b64 vcc, 0xffff
    s_lshl_b64 vcc, vcc, 0
    v_cndmask_b32 v188, 0, v30, vcc
    v_cndmask_b32 v189, 0, v30, vcc
    v_mfma_f32_16x16x32_bf16 v[116:119], v[76:79], v[92:95], v[116:119]
    s_mov_b64 vcc, 0xffff
    s_lshl_b64 vcc, vcc, 16
    v_cndmask_b32 v192, 0, v30, vcc
    v_cndmask_b32 v193, 0, v30, vcc
    ds_read_b128 v[76:79], v5 offset:25600
    v_mfma_f32_16x16x32_bf16 v[104:107], v[80:83], v[88:91], v[104:107]
    s_mov_b64 vcc, 0xffff
    s_lshl_b64 vcc, vcc, 32
    v_cndmask_b32 v196, 0, v30, vcc
    v_cndmask_b32 v197, 0, v30, vcc
    v_mfma_f32_16x16x32_bf16 v[120:123], v[80:83], v[92:95], v[120:123]
    s_mov_b64 vcc, 0xffff
    s_lshl_b64 vcc, vcc, 48
    v_cndmask_b32 v200, 0, v30, vcc
    v_cndmask_b32 v201, 0, v30, vcc
    ds_read_b128 v[80:83], v3 offset:26624
    v_mfma_f32_16x16x32_bf16 v[108:111], v[84:87], v[88:91], v[108:111]
    v_and_b32 v32, 0xffff0000, v130
    v_sub_f32 v32, v130, v32
    v_mfma_f32_16x16x32_bf16 v[124:127], v[84:87], v[92:95], v[124:127]
    v_perm_b32 v136, v32, v130, s84
    v_and_b32 v137, 0xffff0000, v32
    v_sub_f32 v32, v32, v137
    ds_read_b128 v[84:87], v5 offset:27648
    ds_read_b128 v[88:91], v7 offset:24576
    ds_read_b128 v[92:95], v7 offset:28672
    s_waitcnt lgkmcnt(8)
    v_mfma_f32_16x16x32_bf16 v[96:99], v[48:51], v[64:67], v[96:99]
    v_lshrrev_b32 v137, 16, v32
    v_and_b32 v32, 0xffff0000, v132
    v_mfma_f32_16x16x32_bf16 v[112:115], v[48:51], v[68:71], v[112:115]
    v_sub_f32 v32, v132, v32
    v_perm_b32 v138, v32, v132, s84
    v_and_b32 v139, 0xffff0000, v32
    v_mfma_f32_16x16x32_bf16 v[100:103], v[52:55], v[64:67], v[100:103]
    v_sub_f32 v32, v32, v139
    v_lshrrev_b32 v139, 16, v32
    v_mfma_f32_16x16x32_bf16 v[116:119], v[52:55], v[68:71], v[116:119]
    v_lshrrev_b32 v32, 1, v9
    v_add_u32 v32, 149504, v32
    v_lshl_add_u32 v33, v25, 8, v32
    s_waitcnt lgkmcnt(6)
    v_mfma_f32_16x16x32_bf16 v[104:107], v[56:59], v[64:67], v[104:107]
    v_sub_f32 v35, 0, v13
    s_lshl_b32 s15, s6, 14
    v_mfma_f32_16x16x32_bf16 v[120:123], v[56:59], v[68:71], v[120:123]
    s_add_u32 s15, s15, 0xa00000
    s_lshl_b32 s77, s5, 10
    s_add_u32 s77, s77, s15
    v_mfma_f32_16x16x32_bf16 v[108:111], v[60:63], v[64:67], v[108:111]
    v_mfma_f32_16x16x32_bf16 v[124:127], v[60:63], v[68:71], v[124:127]
    ds_write_b32 v46, v29
    ds_write2_b32 v8, v30, v29 offset0:0 offset1:128
    ds_read_b128 v[144:147], v31 offset:0
    ds_read_b128 v[148:151], v31 offset:16
    ds_read_b128 v[152:155], v31 offset:32
    ds_read_b128 v[156:159], v31 offset:48
    s_waitcnt lgkmcnt(6)
    v_mfma_f32_16x16x32_bf16 v[96:99], v[72:75], v[88:91], v[96:99]
    v_mfma_f32_16x16x32_bf16 v[112:115], v[72:75], v[92:95], v[112:115]
    v_mfma_f32_16x16x32_bf16 v[100:103], v[76:79], v[88:91], v[100:103]
    v_mfma_f32_16x16x32_bf16 v[116:119], v[76:79], v[92:95], v[116:119]
    v_mfma_f32_16x16x32_bf16 v[104:107], v[80:83], v[88:91], v[104:107]
    v_mfma_f32_16x16x32_bf16 v[120:123], v[80:83], v[92:95], v[120:123]
    v_mfma_f32_16x16x32_bf16 v[108:111], v[84:87], v[88:91], v[108:111]
    v_mfma_f32_16x16x32_bf16 v[124:127], v[84:87], v[92:95], v[124:127]
    s_nop 1
    v_mfma_f32_16x16x32_bf16 v[96:99], v[188:191], v[136:139], v[96:99]
    v_mfma_f32_16x16x32_bf16 v[100:103], v[192:195], v[136:139], v[100:103]
    v_mfma_f32_16x16x32_bf16 v[104:107], v[196:199], v[136:139], v[104:107]
    v_mfma_f32_16x16x32_bf16 v[108:111], v[200:203], v[136:139], v[108:111]
    v_mfma_f32_16x16x32_bf16 v[112:115], v[186:189], v[136:139], v[112:115]
    v_mfma_f32_16x16x32_bf16 v[116:119], v[190:193], v[136:139], v[116:119]
    v_mfma_f32_16x16x32_bf16 v[120:123], v[194:197], v[136:139], v[120:123]
    v_mfma_f32_16x16x32_bf16 v[124:127], v[198:201], v[136:139], v[124:127]
    s_waitcnt lgkmcnt(0)
    v_mul_f32 v96, v96, v144
    v_mul_f32 v97, v97, v145
    v_mul_f32 v98, v98, v146
    v_mul_f32 v99, v99, v147
    v_mul_f32 v100, v100, v148
    v_mul_f32 v101, v101, v149
    v_mul_f32 v102, v102, v150
    v_mul_f32 v103, v103, v151
    v_mul_f32 v104, v104, v152
    v_mul_f32 v105, v105, v153
    v_mul_f32 v106, v106, v154
    v_mul_f32 v107, v107, v155
    v_mul_f32 v108, v108, v156
    v_mul_f32 v109, v109, v157
    v_mul_f32 v110, v110, v158
    v_mul_f32 v111, v111, v159
    v_mul_f32 v112, v112, v144
    v_mul_f32 v113, v113, v145
    v_mul_f32 v114, v114, v146
    v_mul_f32 v115, v115, v147
    v_mul_f32 v116, v116, v148
    v_mul_f32 v117, v117, v149
    v_mul_f32 v118, v118, v150
    v_mul_f32 v119, v119, v151
    v_mul_f32 v120, v120, v152
    v_mul_f32 v121, v121, v153
    v_mul_f32 v122, v122, v154
    v_mul_f32 v123, v123, v155
    v_mul_f32 v124, v124, v156
    v_mul_f32 v125, v125, v157
    v_mul_f32 v126, v126, v158
    v_mul_f32 v127, v127, v159
    v_fmac_f32 v97, v10, v96
    v_fmac_f32 v113, v10, v112
    v_fmac_f32 v97, v26, v112
    v_fmac_f32 v113, v11, v96
    v_fmac_f32 v98, v10, v97
    v_fmac_f32 v114, v10, v113
    v_fmac_f32 v98, v26, v113
    v_fmac_f32 v114, v11, v97
    v_fmac_f32 v99, v10, v98
    v_fmac_f32 v115, v10, v114
    v_fmac_f32 v99, v26, v114
    v_fmac_f32 v115, v11, v98
    v_fmac_f32 v100, v10, v99
    v_fmac_f32 v116, v10, v115
    v_fmac_f32 v100, v26, v115
    v_fmac_f32 v116, v11, v99
    v_fmac_f32 v101, v10, v100
    v_fmac_f32 v117, v10, v116
    v_fmac_f32 v101, v26, v116
    v_fmac_f32 v117, v11, v100
    v_fmac_f32 v102, v10, v101
    v_fmac_f32 v118, v10, v117
    v_fmac_f32 v102, v26, v117
    v_fmac_f32 v118, v11, v101
    v_fmac_f32 v103, v10, v102
    v_fmac_f32 v119, v10, v118
    v_fmac_f32 v103, v26, v118
    v_fmac_f32 v119, v11, v102
    v_fmac_f32 v104, v10, v103
    v_fmac_f32 v120, v10, v119
    v_fmac_f32 v104, v26, v119
    v_fmac_f32 v120, v11, v103
    v_fmac_f32 v105, v10, v104
    v_fmac_f32 v121, v10, v120
    v_fmac_f32 v105, v26, v120
    v_fmac_f32 v121, v11, v104
    v_fmac_f32 v106, v10, v105
    v_fmac_f32 v122, v10, v121
    v_fmac_f32 v106, v26, v121
    v_fmac_f32 v122, v11, v105
    v_fmac_f32 v107, v10, v106
    v_fmac_f32 v123, v10, v122
    v_fmac_f32 v107, v26, v122
    v_fmac_f32 v123, v11, v106
    v_fmac_f32 v108, v10, v107
    v_fmac_f32 v124, v10, v123
    v_fmac_f32 v108, v26, v123
    v_fmac_f32 v124, v11, v107
    v_fmac_f32 v109, v10, v108
    v_fmac_f32 v125, v10, v124
    v_fmac_f32 v109, v26, v124
    v_fmac_f32 v125, v11, v108
    v_fmac_f32 v110, v10, v109
    v_fmac_f32 v126, v10, v125
    v_fmac_f32 v110, v26, v125
    v_fmac_f32 v126, v11, v109
    v_fmac_f32 v111, v10, v110
    v_fmac_f32 v127, v10, v126
    v_fmac_f32 v111, v26, v126
    v_fmac_f32 v127, v11, v110
    ds_write2_b32 v33, v111, v127 offset0:0 offset1:1
    ds_add_u32 v22, v23 offset:0
    v_mov_b32 v64, s10
    v_mov_b32 v65, s10
    ds_read_b32 v29, v22 offset:0
    ds_read_b64 v[48:49], v32 offset:0
    ds_read_b64 v[50:51], v32 offset:256
    ds_read_b64 v[52:53], v32 offset:512
    ds_read_b64 v[54:55], v32 offset:768
    ds_read_b64 v[56:57], v32 offset:1024
    ds_read_b64 v[58:59], v32 offset:1280
    ds_read_b64 v[60:61], v32 offset:1536
    ds_read_b64 v[62:63], v32 offset:1792
    s_waitcnt lgkmcnt(0)
    v_readfirstlane_b32 s80, v29
    s_cmp_eq_u32 s80, 8
    s_cbranch_scc1 SPD_39
    s_mov_b32 s76, 0x800000
SPIN_38:
    ds_read_b32 v29, v22 offset:0
    s_waitcnt lgkmcnt(0)
    v_readfirstlane_b32 s80, v29
    s_sub_u32 s76, s76, 1
    s_cbranch_scc1 SPR_40
    s_cmp_eq_u32 s80, 8
    s_cbranch_scc1 SPR_40
    s_sleep 1
    s_branch SPIN_38
SPR_40:
    ds_read_b64 v[48:49], v32 offset:0
    ds_read_b64 v[50:51], v32 offset:256
    ds_read_b64 v[52:53], v32 offset:512
    ds_read_b64 v[54:55], v32 offset:768
    ds_read_b64 v[56:57], v32 offset:1024
    ds_read_b64 v[58:59], v32 offset:1280
    ds_read_b64 v[60:61], v32 offset:1536
    ds_read_b64 v[62:63], v32 offset:1792
    s_waitcnt lgkmcnt(0)
SPD_39:
    v_fmac_f32 v50, v12, v48
    v_fmac_f32 v51, v12, v49
    v_fmac_f32 v50, v35, v49
    v_fmac_f32 v51, v13, v48
    v_fmac_f32 v52, v12, v50
    v_fmac_f32 v53, v12, v51
    v_fmac_f32 v52, v35, v51
    v_fmac_f32 v53, v13, v50
    v_fmac_f32 v54, v12, v52
    v_fmac_f32 v55, v12, v53
    v_fmac_f32 v54, v35, v53
    v_fmac_f32 v55, v13, v52
    v_fmac_f32 v56, v12, v54
    v_fmac_f32 v57, v12, v55
    v_fmac_f32 v56, v35, v55
    v_fmac_f32 v57, v13, v54
    v_fmac_f32 v58, v12, v56
    v_fmac_f32 v59, v12, v57
    v_fmac_f32 v58, v35, v57
    v_fmac_f32 v59, v13, v56
    v_fmac_f32 v60, v12, v58
    v_fmac_f32 v61, v12, v59
    v_fmac_f32 v60, v35, v59
    v_fmac_f32 v61, v13, v58
    v_fmac_f32 v62, v12, v60
    v_fmac_f32 v63, v12, v61
    v_fmac_f32 v62, v35, v61
    v_fmac_f32 v63, v13, v60
    s_cmp_ge_u32 s4, 2
    s_cbranch_scc1 NOPUB_41
    s_mov_b64 exec, 0xffff
    buffer_store_dwordx4 v[62:65], v9, s[64:67], s77 offen offset:512 sc1
    s_mov_b64 exec, -1
NOPUB_41:
    s_setprio 0
    s_lshr_b32 s77, s2, 3
    s_mul_i32 s77, s77, 44032
    s_add_u32 s77, s77, 384
    s_add_u32 s78, s77, 43648
    s_mov_b32 s71, 0x20000
    v_lshlrev_b32 v196, 10, v0
    s_mov_b32 s68, s40
    s_mov_b32 s69, s41
    s_cmp_eq_u32 s4, 0
    s_cselect_b32 s70, s78, 0
    buffer_load_dword v197, v196, s[68:71], s77 offen
    s_add_u32 m0, s13, 0
    s_xor_b32 s78, s75, 0
    buffer_load_dwordx4 v36, s[52:55], s78 offen offset:0 lds
    buffer_load_dwordx4 v37, s[52:55], s78 offen offset:1024 lds
    buffer_load_dwordx4 v38, s[52:55], s78 offen offset:2048 lds
    buffer_load_dwordx4 v39, s[52:55], s78 offen offset:3072 lds
    v_mov_b32 v84, 0
    v_mov_b32 v85, 0
    v_sub_f32 v86, 0, v19
    s_add_u32 s68, s46, s15
    s_addc_u32 s69, s47, 0
    s_mov_b32 s70, 16384
    s_mov_b32 s71, 0x20000
    v_subrev_u32 v2, 0, v42
    v_ashrrev_i32 v88, 31, v2
    v_bfi_b32 v88, v88, 0, v64
    v_subrev_u32 v3, 1024, v42
    v_ashrrev_i32 v89, 31, v3
    v_bfi_b32 v89, v89, 0, v64
    v_subrev_u32 v4, 2048, v42
    v_ashrrev_i32 v90, 31, v4
    v_bfi_b32 v90, v90, 0, v64
    v_subrev_u32 v5, 3072, v42
    v_ashrrev_i32 v91, 31, v5
    v_bfi_b32 v91, v91, 0, v64
    v_and_b32 v6, 15, v0
    v_lshrrev_b32 v7, 1, v6
    v_lshrrev_b32 v8, 4, v0
    v_xor_b32 v7, v7, v8
    v_lshl_add_u32 v7, v7, 4, s13
    v_lshl_add_u32 v6, v6, 7, v7
    v_xor_b32 v7, 64, v6
    v_mul_f32 v92, v19, v96
    v_mul_f32 v96, v18, v96
    v_fmac_f32 v96, v86, v112
    v_fma_f32 v112, v18, v112, v92
    v_cmp_eq_u32 vcc, 1, v25
    v_mul_f32 v93, v19, v97
    v_mul_f32 v97, v18, v97
    v_fmac_f32 v97, v86, v113
    v_fma_f32 v113, v18, v113, v93
    v_cndmask_b32 v84, v84, v48, vcc
    v_cndmask_b32 v85, v85, v49, vcc
    v_cmp_eq_u32 vcc, 2, v25
    v_mul_f32 v92, v19, v98
    v_mul_f32 v98, v18, v98
    v_fmac_f32 v98, v86, v114
    v_fma_f32 v114, v18, v114, v92
    v_cndmask_b32 v84, v84, v50, vcc
    v_cndmask_b32 v85, v85, v51, vcc
    v_cmp_eq_u32 vcc, 3, v25
    v_mul_f32 v93, v19, v99
    v_mul_f32 v99, v18, v99
    v_fmac_f32 v99, v86, v115
    v_fma_f32 v115, v18, v115, v93
    v_cndmask_b32 v84, v84, v52, vcc
    v_cndmask_b32 v85, v85, v53, vcc
    s_add_u32 m0, s13, 4096
    s_xor_b32 s78, s74, 0
    buffer_load_dwordx4 v36, s[52:55], s78 offen offset:0 lds
    buffer_load_dwordx4 v37, s[52:55], s78 offen offset:1024 lds
    buffer_load_dwordx4 v38, s[52:55], s78 offen offset:2048 lds
    buffer_load_dwordx4 v39, s[52:55], s78 offen offset:3072 lds
    v_cmp_eq_u32 vcc, 4, v25
    v_mul_f32 v92, v19, v100
    v_mul_f32 v100, v18, v100
    v_fmac_f32 v100, v86, v116
    v_fma_f32 v116, v18, v116, v92
    v_cndmask_b32 v84, v84, v54, vcc
    v_cndmask_b32 v85, v85, v55, vcc
    v_cmp_eq_u32 vcc, 5, v25
    v_mul_f32 v93, v19, v101
    v_mul_f32 v101, v18, v101
    v_fmac_f32 v101, v86, v117
    v_fma_f32 v117, v18, v117, v93
    v_cndmask_b32 v84, v84, v56, vcc
    v_cndmask_b32 v85, v85, v57, vcc
    v_cmp_eq_u32 vcc, 6, v25
    v_mul_f32 v92, v19, v102
    v_mul_f32 v102, v18, v102
    v_fmac_f32 v102, v86, v118
    v_fma_f32 v118, v18, v118, v92
    v_cndmask_b32 v84, v84, v58, vcc
    v_cndmask_b32 v85, v85, v59, vcc
    v_cmp_eq_u32 vcc, 7, v25
    v_mul_f32 v93, v19, v103
    v_mul_f32 v103, v18, v103
    v_fmac_f32 v103, v86, v119
    v_fma_f32 v119, v18, v119, v93
    v_cndmask_b32 v84, v84, v60, vcc
    v_cndmask_b32 v85, v85, v61, vcc
    v_mul_f32 v92, v19, v104
    v_mul_f32 v104, v18, v104
    v_fmac_f32 v104, v86, v120
    v_fma_f32 v120, v18, v120, v92
    s_add_u32 m0, s13, 8192
    s_xor_b32 s78, s75, 0
    buffer_load_dwordx4 v36, s[56:59], s78 offen offset:0 lds
    buffer_load_dwordx4 v37, s[56:59], s78 offen offset:1024 lds
    buffer_load_dwordx4 v38, s[56:59], s78 offen offset:2048 lds
    buffer_load_dwordx4 v39, s[56:59], s78 offen offset:3072 lds
    v_mul_f32 v93, v19, v105
    v_mul_f32 v105, v18, v105
    v_fmac_f32 v105, v86, v121
    v_fma_f32 v121, v18, v121, v93
    v_mul_f32 v92, v19, v106
    v_mul_f32 v106, v18, v106
    v_fmac_f32 v106, v86, v122
    v_fma_f32 v122, v18, v122, v92
    v_mul_f32 v93, v19, v107
    v_mul_f32 v107, v18, v107
    v_fmac_f32 v107, v86, v123
    v_fma_f32 v123, v18, v123, v93
    v_mul_f32 v92, v19, v108
    v_mul_f32 v108, v18, v108
    v_fmac_f32 v108, v86, v124
    v_fma_f32 v124, v18, v124, v92
    v_mul_f32 v93, v19, v109
    v_mul_f32 v109, v18, v109
    v_fmac_f32 v109, v86, v125
    v_fma_f32 v125, v18, v125, v93
    v_mul_f32 v92, v19, v110
    v_mul_f32 v110, v18, v110
    v_fmac_f32 v110, v86, v126
    v_fma_f32 v126, v18, v126, v92
    v_mul_f32 v93, v19, v111
    v_mul_f32 v111, v18, v111
    v_fmac_f32 v111, v86, v127
    v_fma_f32 v127, v18, v127, v93
    buffer_load_dwordx4 v[68:71], v2, s[68:71], 0 offen sc1
    buffer_load_dwordx4 v[72:75], v3, s[68:71], 0 offen sc1
    buffer_load_dwordx4 v[76:79], v4, s[68:71], 0 offen sc1
    buffer_load_dwordx4 v[80:83], v5, s[68:71], 0 offen sc1
    v_mul_f32 v208, v10, v18
    v_mul_f32 v240, v10, v19
    v_fmac_f32 v208, v26, v19
    v_fmac_f32 v240, v11, v18
    v_mul_f32 v209, v10, v208
    v_mul_f32 v241, v10, v240
    v_fmac_f32 v209, v26, v240
    v_fmac_f32 v241, v11, v208
    v_mul_f32 v210, v10, v209
    v_mul_f32 v242, v10, v241
    v_fmac_f32 v210, v26, v241
    v_fmac_f32 v242, v11, v209
    v_mul_f32 v211, v10, v210
    v_mul_f32 v243, v10, v242
    v_fmac_f32 v211, v26, v242
    v_fmac_f32 v243, v11, v210
    v_mul_f32 v212, v10, v211
    v_mul_f32 v244, v10, v243
    v_fmac_f32 v212, v26, v243
    v_fmac_f32 v244, v11, v211
    v_mul_f32 v213, v10, v212
    v_mul_f32 v245, v10, v244
    v_fmac_f32 v213, v26, v244
    v_fmac_f32 v245, v11, v212
    v_mul_f32 v214, v10, v213
    v_mul_f32 v246, v10, v245
    v_fmac_f32 v214, v26, v245
    v_fmac_f32 v246, v11, v213
    v_mul_f32 v215, v10, v214
    v_mul_f32 v247, v10, v246
    v_fmac_f32 v215, v26, v246
    v_fmac_f32 v247, v11, v214
    v_mul_f32 v216, v10, v215
    v_mul_f32 v248, v10, v247
    v_fmac_f32 v216, v26, v247
    v_fmac_f32 v248, v11, v215
    v_mul_f32 v217, v10, v216
    v_mul_f32 v249, v10, v248
    v_fmac_f32 v217, v26, v248
    v_fmac_f32 v249, v11, v216
    v_mul_f32 v218, v10, v217
    v_mul_f32 v250, v10, v249
    v_fmac_f32 v218, v26, v249
    v_fmac_f32 v250, v11, v217
    v_mul_f32 v219, v10, v218
    v_mul_f32 v251, v10, v250
    v_fmac_f32 v219, v26, v250
    v_fmac_f32 v251, v11, v218
    v_mul_f32 v220, v10, v219
    v_mul_f32 v252, v10, v251
    v_fmac_f32 v220, v26, v251
    v_fmac_f32 v252, v11, v219
    v_mul_f32 v221, v10, v220
    v_mul_f32 v253, v10, v252
    v_fmac_f32 v221, v26, v252
    v_fmac_f32 v253, v11, v220
    v_mul_f32 v222, v10, v221
    v_mul_f32 v254, v10, v253
    v_fmac_f32 v222, v26, v253
    v_fmac_f32 v254, v11, v221
    v_mul_f32 v223, v10, v222
    v_mul_f32 v255, v10, v254
    v_fmac_f32 v223, v26, v254
    v_fmac_f32 v255, v11, v222
    s_waitcnt vmcnt(12)
    ds_read_b128 v[128:131], v6 offset:0
    ds_read_b128 v[132:135], v6 offset:2048
    ds_read_b128 v[160:163], v7 offset:0
    ds_read_b128 v[164:167], v7 offset:2048
    s_waitcnt lgkmcnt(0)
    s_add_u32 m0, s13, 0
    s_xor_b32 s78, s74, 0
    buffer_load_dwordx4 v36, s[56:59], s78 offen offset:0 lds
    buffer_load_dwordx4 v37, s[56:59], s78 offen offset:1024 lds
    buffer_load_dwordx4 v38, s[56:59], s78 offen offset:2048 lds
    buffer_load_dwordx4 v39, s[56:59], s78 offen offset:3072 lds
    s_waitcnt vmcnt(12)
    ds_read_b128 v[136:139], v6 offset:4096
    ds_read_b128 v[140:143], v6 offset:6144
    ds_read_b128 v[168:171], v7 offset:4096
    ds_read_b128 v[172:175], v7 offset:6144
    s_waitcnt lgkmcnt(0)
    s_add_u32 m0, s13, 4096
    s_xor_b32 s78, s75, 128
    buffer_load_dwordx4 v36, s[52:55], s78 offen offset:0 lds
    buffer_load_dwordx4 v37, s[52:55], s78 offen offset:1024 lds
    buffer_load_dwordx4 v38, s[52:55], s78 offen offset:2048 lds
    buffer_load_dwordx4 v39, s[52:55], s78 offen offset:3072 lds
    s_mov_b32 s76, 0x200000
    s_waitcnt vmcnt(8)
LB_42:
    v_cmp_ne_u32 vcc, v88, v70
    v_cmp_ne_u32 s[100:101], v89, v74
    s_or_b64 vcc, vcc, s[100:101]
    v_cmp_ne_u32 s[100:101], v90, v78
    s_or_b64 vcc, vcc, s[100:101]
    v_cmp_ne_u32 s[100:101], v91, v82
    s_or_b64 vcc, vcc, s[100:101]
    s_cbranch_scc0 LBD_43
    s_sub_u32 s76, s76, 1
    s_cbranch_scc1 LBD_43
    s_sleep 2
    buffer_load_dwordx4 v[68:71], v2, s[68:71], 0 offen sc1
    buffer_load_dwordx4 v[72:75], v3, s[68:71], 0 offen sc1
    buffer_load_dwordx4 v[76:79], v4, s[68:71], 0 offen sc1
    buffer_load_dwordx4 v[80:83], v5, s[68:71], 0 offen sc1
    s_waitcnt vmcnt(0)
    s_branch LB_42
LBD_43:
    s_setprio 2
    ds_read_b128 v[144:147], v6 offset:8192
    ds_read_b128 v[148:151], v6 offset:10240
    ds_read_b128 v[176:179], v7 offset:8192
    ds_read_b128 v[180:183], v7 offset:10240
    v_fma_f32 v76, v14, v80, v76
    v_fma_f32 v77, v14, v81, v77
    v_fma_f32 v76, -v15, v81, v76
    v_fmac_f32 v77, v15, v80
    v_fma_f32 v72, v14, v76, v72
    v_fma_f32 v73, v14, v77, v73
    v_fma_f32 v72, -v15, v77, v72
    v_fmac_f32 v73, v15, v76
    v_fma_f32 v68, v14, v72, v68
    v_fma_f32 v69, v14, v73, v69
    v_fma_f32 v68, -v15, v73, v68
    v_fmac_f32 v69, v15, v72
    v_mul_f32 v48, v16, v68
    v_mul_f32 v49, v16, v69
    v_fma_f32 v48, -v17, v69, v48
    v_fmac_f32 v49, v17, v68
    s_nop 1
    v_permlane32_swap_b32 v48, v49
    v_add_f32 v48, v48, v49
    v_mov_b32 v49, v48
    s_nop 1
    v_permlane16_swap_b32 v48, v49
    v_add_f32 v48, v48, v49
    v_mov_b32 v49, v48
    s_waitcnt lgkmcnt(0)
    s_nop 0
    v_permlane32_swap_b32 v48, v49
    v_fma_f32 v84, v20, v48, v84
    v_fma_f32 v85, v20, v49, v85
    v_fma_f32 v84, -v21, v49, v84
    v_fmac_f32 v85, v21, v48
    v_sub_f32 v86, 0, v85
    s_add_u32 m0, s13, 8192
    s_xor_b32 s78, s74, 128
    buffer_load_dwordx4 v36, s[52:55], s78 offen offset:0 lds
    v_fmac_f32 v96, v208, v84
    v_fmac_f32 v97, v209, v84
    v_fmac_f32 v98, v210, v84
    v_fmac_f32 v99, v211, v84
    buffer_load_dwordx4 v37, s[52:55], s78 offen offset:1024 lds
    v_fmac_f32 v100, v212, v84
    v_fmac_f32 v101, v213, v84
    v_fmac_f32 v102, v214, v84
    v_fmac_f32 v103, v215, v84
    buffer_load_dwordx4 v38, s[52:55], s78 offen offset:2048 lds
    v_fmac_f32 v104, v216, v84
    v_fmac_f32 v105, v217, v84
    v_fmac_f32 v106, v218, v84
    v_fmac_f32 v107, v219, v84
    buffer_load_dwordx4 v39, s[52:55], s78 offen offset:3072 lds
    v_fmac_f32 v108, v220, v84
    v_fmac_f32 v109, v221, v84
    v_fmac_f32 v110, v222, v84
    v_fmac_f32 v111, v223, v84
    v_fmac_f32 v96, v240, v86
    v_fmac_f32 v97, v241, v86
    v_fmac_f32 v98, v242, v86
    v_fmac_f32 v99, v243, v86
    v_fmac_f32 v100, v244, v86
    v_fmac_f32 v101, v245, v86
    v_fmac_f32 v102, v246, v86
    v_fmac_f32 v103, v247, v86
    v_fmac_f32 v104, v248, v86
    v_fmac_f32 v105, v249, v86
    v_fmac_f32 v106, v250, v86
    v_fmac_f32 v107, v251, v86
    v_fmac_f32 v108, v252, v86
    v_fmac_f32 v109, v253, v86
    v_fmac_f32 v110, v254, v86
    v_fmac_f32 v111, v255, v86
    v_cvt_pk_bf16_f32 v48, v96, v97
    v_cvt_pk_bf16_f32 v49, v98, v99
    v_cvt_pk_bf16_f32 v50, v100, v101
    v_cvt_pk_bf16_f32 v51, v102, v103
    v_cvt_pk_bf16_f32 v52, v104, v105
    v_cvt_pk_bf16_f32 v53, v106, v107
    v_cvt_pk_bf16_f32 v54, v108, v109
    v_cvt_pk_bf16_f32 v55, v110, v111
    ds_write_b128 v40, v[48:51]
    ds_write_b128 v44, v[52:55]
    ds_read_b64_tr_b16 v[64:65], v41 offset:0
    ds_read_b64_tr_b16 v[66:67], v45 offset:512
    ds_read_b64_tr_b16 v[68:69], v45 offset:0
    ds_read_b64_tr_b16 v[70:71], v41 offset:512
    s_waitcnt vmcnt(4)
    ds_read_b128 v[152:155], v6 offset:0
    ds_read_b128 v[156:159], v6 offset:2048
    ds_read_b128 v[184:187], v7 offset:0
    ds_read_b128 v[188:191], v7 offset:2048
    ds_read_b128 v[192:195], v6 offset:4096
    ds_read_b128 v[196:199], v6 offset:6144
    ds_read_b128 v[224:227], v7 offset:4096
    ds_read_b128 v[228:231], v7 offset:6144
    v_fmac_f32 v112, v208, v85
    v_fmac_f32 v113, v209, v85
    v_fmac_f32 v114, v210, v85
    v_fmac_f32 v115, v211, v85
    v_fmac_f32 v116, v212, v85
    v_fmac_f32 v117, v213, v85
    v_fmac_f32 v118, v214, v85
    v_fmac_f32 v119, v215, v85
    v_fmac_f32 v120, v216, v85
    v_fmac_f32 v121, v217, v85
    v_fmac_f32 v122, v218, v85
    v_fmac_f32 v123, v219, v85
    v_fmac_f32 v124, v220, v85
    v_fmac_f32 v125, v221, v85
    v_fmac_f32 v126, v222, v85
    v_fmac_f32 v127, v223, v85
    s_waitcnt lgkmcnt(0)
    buffer_store_dwordx4 v[64:67], v47, s[64:67], s11 offen offset:0 sc1
    buffer_store_dwordx4 v[68:71], v47, s[64:67], s82 offen offset:0 sc1
    s_add_u32 m0, s13, 0
    s_xor_b32 s78, s75, 128
    buffer_load_dwordx4 v36, s[56:59], s78 offen offset:0 lds
    v_fmac_f32 v112, v240, v84
    v_fmac_f32 v113, v241, v84
    v_fmac_f32 v114, v242, v84
    buffer_load_dwordx4 v37, s[56:59], s78 offen offset:1024 lds
    v_fmac_f32 v115, v243, v84
    v_fmac_f32 v116, v244, v84
    v_fmac_f32 v117, v245, v84
    buffer_load_dwordx4 v38, s[56:59], s78 offen offset:2048 lds
    v_fmac_f32 v118, v246, v84
    v_fmac_f32 v119, v247, v84
    v_fmac_f32 v120, v248, v84
    buffer_load_dwordx4 v39, s[56:59], s78 offen offset:3072 lds
    v_fmac_f32 v121, v249, v84
    v_fmac_f32 v122, v250, v84
    v_fmac_f32 v123, v251, v84
    s_add_u32 m0, s13, 4096
    s_xor_b32 s78, s74, 128
    buffer_load_dwordx4 v36, s[56:59], s78 offen offset:0 lds
    v_fmac_f32 v124, v252, v84
    v_fmac_f32 v125, v253, v84
    v_fmac_f32 v126, v254, v84
    buffer_load_dwordx4 v37, s[56:59], s78 offen offset:1024 lds
    v_fmac_f32 v127, v255, v84
    buffer_load_dwordx4 v38, s[56:59], s78 offen offset:2048 lds
    v_cvt_pk_bf16_f32 v56, -v112, -v113
    v_cvt_pk_bf16_f32 v57, -v114, -v115
    v_cvt_pk_bf16_f32 v58, -v116, -v117
    v_cvt_pk_bf16_f32 v59, -v118, -v119
    buffer_load_dwordx4 v39, s[56:59], s78 offen offset:3072 lds
    v_cvt_pk_bf16_f32 v60, -v120, -v121
    v_cvt_pk_bf16_f32 v61, -v122, -v123
    v_cvt_pk_bf16_f32 v62, -v124, -v125
    v_cvt_pk_bf16_f32 v63, -v126, -v127
    ds_write_b128 v40, v[56:59]
    ds_write_b128 v44, v[60:63]
    ds_read_b64_tr_b16 v[72:73], v41 offset:0
    ds_read_b64_tr_b16 v[74:75], v45 offset:512
    ds_read_b64_tr_b16 v[76:77], v45 offset:0
    ds_read_b64_tr_b16 v[78:79], v41 offset:512
    s_waitcnt lgkmcnt(0)
    buffer_store_dwordx4 v[72:75], v47, s[64:67], s11 offen offset:2048 sc1
    buffer_store_dwordx4 v[76:79], v47, s[64:67], s82 offen offset:2048 sc1
    s_setprio 0
    s_lshr_b32 s77, s4, 1
    s_lshl_b32 s78, s7, 1
    s_add_u32 s77, s77, s78
    s_lshl_b32 s78, s8, 7
    s_and_b32 s79, s4, 1
    s_lshl_b32 s79, s79, 6
    s_add_u32 s78, s78, s79
    s_lshl_b32 s79, s77, 15
    s_add_u32 s79, s79, s78
    s_lshl_b32 s77, s77, 9
    s_add_u32 s77, s77, 0xa50000
    v_and_b32 v28, 31, v0
    v_and_b32 v16, 16, v0
    v_add_u32 v16, v16, v28
    v_lshl_add_u32 v16, v16, 3, s77
    v_and_b32 v28, 15, v0
    v_lshl_add_u32 v28, v28, 1, s78
    v_lshrrev_b32 v29, 2, v0
    v_and_b32 v30, 3, v0
    v_lshlrev_b32 v30, 4, v30
    v_lshl_or_b32 v29, v29, 10, v30
    v_add_u32 v30, 15360, v29
    s_lshl_b32 s33, s4, 11
    s_add_u32 s33, s33, 155648
    s_mov_b32 m0, s33
    global_load_ushort v1, v28, s[34:35]
    global_load_ushort v8, v28, s[34:35] offset:32
    buffer_load_dwordx4 v29, s[48:51], s79 offen lds
    buffer_load_dwordx4 v30, s[48:51], s79 offen offset:1024 lds
    buffer_load_dwordx2 v[12:13], v16, s[64:67], 0 offen sc1
    v_lshrrev_b32 v31, 3, v0
    v_and_b32 v32, 7, v0
    v_lshrrev_b32 v33, 4, v0
    v_lshlrev_b32 v33, 1, v33
    v_xor_b32 v32, v32, v33
    v_lshlrev_b32 v32, 4, v32
    v_lshl_or_b32 v2, v31, 10, v32
    v_add_u32 v3, 7168, v2
    v_add_u32 v4, 14336, v2
    s_mul_i32 s14, s4, 6144
    s_mul_i32 s12, s4, 49152
    s_lshl_b32 s32, s8, 7
    s_add_u32 s12, s12, s32
    s_lshr_b32 s78, s4, 1
    s_lshl1_add_u32 s77, s5, s78
    s_lshr_b32 s78, s6, 2
    s_lshl2_add_u32 s77, s77, s78
    s_lshl_b32 s77, s77, 8
    s_and_b32 s78, s4, 1
    s_lshl4_add_u32 s77, s78, s77
    s_and_b32 s78, s6, 3
    s_lshl2_add_u32 s77, s78, s77
    s_add_u32 s77, s77, 0xa48000
    v_mov_b32 v28, s10
    v_lshlrev_b32 v24, 8, v0
    s_waitcnt vmcnt(5)
    s_mov_b64 exec, 1
    buffer_store_dword v28, v24, s[64:67], s77 offen sc1
    s_mov_b64 exec, -1
    s_mov_b32 s76, 0x800000
SPIN_44:
    ds_read_b32 v28, v22 offset:28
    s_waitcnt lgkmcnt(0)
    v_readfirstlane_b32 s80, v28
    s_sub_u32 s76, s76, 1
    s_cbranch_scc1 SPR_46
    s_cmp_eq_u32 s80, 4
    s_cbranch_scc1 SPR_46
    s_sleep 1
    s_branch SPIN_44
SPR_46:
SPD_45:
    s_add_u32 m0, s14, 122880
    s_add_u32 s78, s12, 1081344
    buffer_load_dwordx4 v2, s[60:63], s78 offen offset:0 lds
    buffer_load_dwordx4 v3, s[60:63], s78 offen offset:1024 lds
    buffer_load_dwordx4 v4, s[60:63], s78 offen offset:2048 lds
    s_add_u32 m0, s14, 125952
    s_add_u32 s78, s12, 1105920
    buffer_load_dwordx4 v2, s[60:63], s78 offen offset:0 lds
    buffer_load_dwordx4 v3, s[60:63], s78 offen offset:1024 lds
    buffer_load_dwordx4 v4, s[60:63], s78 offen offset:2048 lds
    s_lshl2_add_u32 s26, s7, s4
    s_lshl_b32 s26, s26, 8
    s_add_u32 s26, s26, 0xa48000
    s_mov_b32 s24, s10
    s_mov_b32 s25, s10
    s_load_dwordx8 s[16:23], s[46:47], s26 glc
    s_waitcnt vmcnt(6)
    ds_add_u32 v22, v23 offset:48
    ds_read_b128 v[200:203], v6 offset:8192
    ds_read_b128 v[204:207], v6 offset:10240
    ds_read_b128 v[232:235], v7 offset:8192
    ds_read_b128 v[236:239], v7 offset:10240
    ds_read_b128 v[208:211], v6 offset:0
    ds_read_b128 v[212:215], v6 offset:2048
    ds_read_b128 v[240:243], v7 offset:0
    ds_read_b128 v[244:247], v7 offset:2048
    ds_read_b128 v[216:219], v6 offset:4096
    ds_read_b128 v[220:223], v6 offset:6144
    ds_read_b128 v[248:251], v7 offset:4096
    ds_read_b128 v[252:255], v7 offset:6144
    s_mov_b32 s76, 0x200000
    s_waitcnt vmcnt(6)
RC_47:
    v_cmp_ne_u32 vcc, s10, v13
    s_cmp_eq_u64 vcc, 0
    s_cbranch_scc1 RCD_48
    s_sub_u32 s76, s76, 1
    s_cbranch_scc1 RCD_48
    s_sleep 2
    buffer_load_dwordx2 v[12:13], v16, s[64:67], 0 offen sc1
    s_waitcnt vmcnt(0)
    s_branch RC_47
RCD_48:
    v_lshlrev_b32 v32, 16, v12
    v_and_b32 v33, 0xffff0000, v12
    v_rcp_f32 v33, v33
    v_and_b32 v30, 31, v0
    s_lshl_b32 s77, s4, 7
    s_add_u32 s77, s77, 147456
    v_lshl_add_u32 v30, v30, 2, s77
    ds_write2st64_b32 v30, v32, v33 offset0:0 offset1:30
    v_and_b32 v34, 16, v0
    v_lshrrev_b32 v35, 5, v0
    v_lshl_add_u32 v34, v35, 2, v34
    v_lshl_add_u32 v31, v34, 2, s77
    v_bfe_u32 v35, v0, 2, 2
    v_add_lshl_u32 v34, v34, v35, 6
    v_and_b32 v35, 3, v0
    v_lshl_add_u32 v34, v35, 3, v34
    v_add_u32 v34, s33, v34
    s_waitcnt lgkmcnt(3)
    ds_read_b64_tr_b16 v[80:81], v34 offset:0
    ds_read_b64_tr_b16 v[82:83], v34 offset:32
    ds_read_b64_tr_b16 v[84:85], v34 offset:512
    ds_read_b64_tr_b16 v[86:87], v34 offset:544
    ds_read_b128 v[96:99], v31 offset:0
    ds_read_b128 v[100:103], v31 offset:0
    ds_read_b128 v[104:107], v31 offset:32
    ds_read_b128 v[108:111], v31 offset:32
    ds_read_b128 v[112:115], v31 offset:7680
    ds_read_b128 v[116:119], v31 offset:7712
    v_lshrrev_b32 v35, 4, v0
    v_and_b32 v47, 15, v0
    v_lshlrev_b32 v47, 4, v47
    v_lshl_or_b32 v47, v35, 9, v47
    s_lshr_b32 s77, s4, 1
    s_mul_i32 s78, s77, 163840
    s_xor_b32 s79, s78, 163840
    v_add_u32 v10, s78, v47
    v_add_u32 v11, s79, v47
    s_mul_i32 s73, s7, 327680
    s_lshl_b32 s77, s4, 14
    s_add_u32 s73, s73, s77
    v_mov_b32 v14, v22
    v_mov_b32 v15, 1
    v_lshlrev_b32 v1, 16, v1
    v_lshlrev_b32 v8, 16, v8
    s_mov_b32 s32, 0xffff0000
    s_mov_b32 s76, 0x200000
POLL_49:
    s_waitcnt lgkmcnt(0)
    s_xor_b64 s[16:17], s[16:17], s[24:25]
    s_xor_b64 s[18:19], s[18:19], s[24:25]
    s_xor_b64 s[20:21], s[20:21], s[24:25]
    s_xor_b64 s[22:23], s[22:23], s[24:25]
    s_or_b64 s[16:17], s[16:17], s[18:19]
    s_or_b64 s[20:21], s[20:21], s[22:23]
    s_or_b64 s[16:17], s[16:17], s[20:21]
    s_cbranch_scc0 PLD_50
    s_sub_u32 s76, s76, 1
    s_cbranch_scc1 PLD_50
    s_load_dwordx8 s[16:23], s[46:47], s26 glc
    s_branch POLL_49
PLD_50:
    s_setprio 2
    s_add_u32 s77, s73, 0
    buffer_load_dwordx4 v[16:19], v10, s[64:67], s77 offen offset:0 sc1
    buffer_load_dwordx4 v[20:23], v11, s[64:67], s77 offen offset:0 sc1
    buffer_load_dwordx4 v[24:27], v10, s[64:67], s77 offen offset:256 sc1
    buffer_load_dwordx4 v[28:31], v11, s[64:67], s77 offen offset:256 sc1
    buffer_load_dwordx4 v[32:35], v10, s[64:67], s77 offen offset:2048 sc1
    buffer_load_dwordx4 v[36:39], v11, s[64:67], s77 offen offset:2048 sc1
    buffer_load_dwordx4 v[40:43], v10, s[64:67], s77 offen offset:2304 sc1
    buffer_load_dwordx4 v[44:47], v11, s[64:67], s77 offen offset:2304 sc1
    s_add_u32 s77, s73, 4096
    buffer_load_dwordx4 v[48:51], v10, s[64:67], s77 offen offset:0 sc1
    buffer_load_dwordx4 v[52:55], v11, s[64:67], s77 offen offset:0 sc1
    buffer_load_dwordx4 v[56:59], v10, s[64:67], s77 offen offset:256 sc1
    buffer_load_dwordx4 v[60:63], v11, s[64:67], s77 offen offset:256 sc1
    s_waitcnt vmcnt(12)
    ds_add_u32 v14, v15 offset:52
    v_lshlrev_b32 v64, 16, v80
    v_and_b32 v65, s32, v80
    v_sub_f32 v96, v64, v96
    v_sub_f32 v97, v65, v97
    v_cvt_pk_bf16_f32 v97, v96, v97
    v_lshlrev_b32 v96, 16, v97
    v_and_b32 v97, s32, v97
    v_mul_f32 v96, v96, v112
    v_mul_f32 v97, v97, v113
    v_cvt_pk_bf16_f32 v97, v96, v97
    v_lshlrev_b32 v96, 16, v97
    v_and_b32 v97, s32, v97
    v_mul_f32 v96, v96, v1
    v_mul_f32 v97, v97, v1
    v_cvt_pk_bf16_f32 v97, v96, v97
    v_lshlrev_b32 v96, 16, v97
    v_and_b32 v97, s32, v97
    v_add_f32 v64, v64, v96
    v_add_f32 v65, v65, v97
    v_lshlrev_b32 v66, 16, v81
    v_and_b32 v67, s32, v81
    v_sub_f32 v98, v66, v98
    v_sub_f32 v99, v67, v99
    v_cvt_pk_bf16_f32 v99, v98, v99
    v_lshlrev_b32 v98, 16, v99
    v_and_b32 v99, s32, v99
    v_mul_f32 v98, v98, v114
    v_mul_f32 v99, v99, v115
    v_cvt_pk_bf16_f32 v99, v98, v99
    v_lshlrev_b32 v98, 16, v99
    v_and_b32 v99, s32, v99
    v_mul_f32 v98, v98, v1
    v_mul_f32 v99, v99, v1
    v_cvt_pk_bf16_f32 v99, v98, v99
    v_lshlrev_b32 v98, 16, v99
    v_and_b32 v99, s32, v99
    v_add_f32 v66, v66, v98
    v_add_f32 v67, v67, v99
    v_lshlrev_b32 v68, 16, v82
    v_and_b32 v69, s32, v82
    v_sub_f32 v100, v68, v100
    v_sub_f32 v101, v69, v101
    v_cvt_pk_bf16_f32 v101, v100, v101
    v_lshlrev_b32 v100, 16, v101
    v_and_b32 v101, s32, v101
    v_mul_f32 v100, v100, v112
    v_mul_f32 v101, v101, v113
    v_cvt_pk_bf16_f32 v101, v100, v101
    v_lshlrev_b32 v100, 16, v101
    v_and_b32 v101, s32, v101
    v_mul_f32 v100, v100, v8
    v_mul_f32 v101, v101, v8
    v_cvt_pk_bf16_f32 v101, v100, v101
    v_lshlrev_b32 v100, 16, v101
    v_and_b32 v101, s32, v101
    v_add_f32 v68, v68, v100
    v_add_f32 v69, v69, v101
    v_lshlrev_b32 v70, 16, v83
    v_and_b32 v71, s32, v83
    v_sub_f32 v102, v70, v102
    v_sub_f32 v103, v71, v103
    v_cvt_pk_bf16_f32 v103, v102, v103
    v_lshlrev_b32 v102, 16, v103
    v_and_b32 v103, s32, v103
    v_mul_f32 v102, v102, v114
    v_mul_f32 v103, v103, v115
    v_cvt_pk_bf16_f32 v103, v102, v103
    v_lshlrev_b32 v102, 16, v103
    v_and_b32 v103, s32, v103
    v_mul_f32 v102, v102, v8
    v_mul_f32 v103, v103, v8
    v_cvt_pk_bf16_f32 v103, v102, v103
    v_lshlrev_b32 v102, 16, v103
    v_and_b32 v103, s32, v103
    v_add_f32 v70, v70, v102
    v_add_f32 v71, v71, v103
    v_lshlrev_b32 v72, 16, v84
    v_and_b32 v73, s32, v84
    v_sub_f32 v104, v72, v104
    v_sub_f32 v105, v73, v105
    v_cvt_pk_bf16_f32 v105, v104, v105
    v_lshlrev_b32 v104, 16, v105
    v_and_b32 v105, s32, v105
    v_mul_f32 v104, v104, v116
    v_mul_f32 v105, v105, v117
    v_cvt_pk_bf16_f32 v105, v104, v105
    v_lshlrev_b32 v104, 16, v105
    v_and_b32 v105, s32, v105
    v_mul_f32 v104, v104, v1
    v_mul_f32 v105, v105, v1
    v_cvt_pk_bf16_f32 v105, v104, v105
    v_lshlrev_b32 v104, 16, v105
    v_and_b32 v105, s32, v105
    v_add_f32 v72, v72, v104
    v_add_f32 v73, v73, v105
    v_lshlrev_b32 v74, 16, v85
    v_and_b32 v75, s32, v85
    v_sub_f32 v106, v74, v106
    v_sub_f32 v107, v75, v107
    v_cvt_pk_bf16_f32 v107, v106, v107
    v_lshlrev_b32 v106, 16, v107
    v_and_b32 v107, s32, v107
    v_mul_f32 v106, v106, v118
    v_mul_f32 v107, v107, v119
    v_cvt_pk_bf16_f32 v107, v106, v107
    v_lshlrev_b32 v106, 16, v107
    v_and_b32 v107, s32, v107
    v_mul_f32 v106, v106, v1
    v_mul_f32 v107, v107, v1
    v_cvt_pk_bf16_f32 v107, v106, v107
    v_lshlrev_b32 v106, 16, v107
    v_and_b32 v107, s32, v107
    v_add_f32 v74, v74, v106
    v_add_f32 v75, v75, v107
    v_lshlrev_b32 v76, 16, v86
    v_and_b32 v77, s32, v86
    v_sub_f32 v108, v76, v108
    v_sub_f32 v109, v77, v109
    v_cvt_pk_bf16_f32 v109, v108, v109
    v_lshlrev_b32 v108, 16, v109
    v_and_b32 v109, s32, v109
    v_mul_f32 v108, v108, v116
    v_mul_f32 v109, v109, v117
    v_cvt_pk_bf16_f32 v109, v108, v109
    v_lshlrev_b32 v108, 16, v109
    v_and_b32 v109, s32, v109
    v_mul_f32 v108, v108, v8
    v_mul_f32 v109, v109, v8
    v_cvt_pk_bf16_f32 v109, v108, v109
    v_lshlrev_b32 v108, 16, v109
    v_and_b32 v109, s32, v109
    v_add_f32 v76, v76, v108
    v_add_f32 v77, v77, v109
    v_lshlrev_b32 v78, 16, v87
    v_and_b32 v79, s32, v87
    v_sub_f32 v110, v78, v110
    v_sub_f32 v111, v79, v111
    v_cvt_pk_bf16_f32 v111, v110, v111
    v_lshlrev_b32 v110, 16, v111
    v_and_b32 v111, s32, v111
    v_mul_f32 v110, v110, v118
    v_mul_f32 v111, v111, v119
    v_cvt_pk_bf16_f32 v111, v110, v111
    v_lshlrev_b32 v110, 16, v111
    v_and_b32 v111, s32, v111
    v_mul_f32 v110, v110, v8
    v_mul_f32 v111, v111, v8
    v_cvt_pk_bf16_f32 v111, v110, v111
    v_lshlrev_b32 v110, 16, v111
    v_and_b32 v111, s32, v111
    v_add_f32 v78, v78, v110
    v_add_f32 v79, v79, v111
    s_nop 1
    s_waitcnt vmcnt(11)
    v_mfma_f32_16x16x32_bf16 v[64:67], v[16:19], v[128:131], v[64:67]
    v_mfma_f32_16x16x32_bf16 v[68:71], v[16:19], v[132:135], v[68:71]
    v_mfma_f32_16x16x32_bf16 v[80:83], v[16:19], v[136:139], 0
    v_mfma_f32_16x16x32_bf16 v[84:87], v[16:19], v[140:143], 0
    s_waitcnt vmcnt(10)
    v_mfma_f32_16x16x32_bf16 v[96:99], v[20:23], v[128:131], 0
    buffer_load_dwordx4 v[16:19], v10, s[64:67], s77 offen offset:2048 sc1
    v_mfma_f32_16x16x32_bf16 v[100:103], v[20:23], v[132:135], 0
    v_mfma_f32_16x16x32_bf16 v[112:115], v[20:23], v[136:139], 0
    v_mfma_f32_16x16x32_bf16 v[116:119], v[20:23], v[140:143], 0
    s_waitcnt vmcnt(10)
    v_mfma_f32_16x16x32_bf16 v[72:75], v[24:27], v[128:131], v[72:75]
    buffer_load_dwordx4 v[20:23], v11, s[64:67], s77 offen offset:2048 sc1
    v_mfma_f32_16x16x32_bf16 v[76:79], v[24:27], v[132:135], v[76:79]
    v_mfma_f32_16x16x32_bf16 v[88:91], v[24:27], v[136:139], 0
    v_mfma_f32_16x16x32_bf16 v[92:95], v[24:27], v[140:143], 0
    s_waitcnt vmcnt(10)
    v_mfma_f32_16x16x32_bf16 v[104:107], v[28:31], v[128:131], 0
    buffer_load_dwordx4 v[24:27], v10, s[64:67], s77 offen offset:2304 sc1
    v_mfma_f32_16x16x32_bf16 v[108:111], v[28:31], v[132:135], 0
    v_mfma_f32_16x16x32_bf16 v[120:123], v[28:31], v[136:139], 0
    v_mfma_f32_16x16x32_bf16 v[124:127], v[28:31], v[140:143], 0
    s_waitcnt vmcnt(10)
    v_mfma_f32_16x16x32_bf16 v[64:67], v[32:35], v[144:147], v[64:67]
    buffer_load_dwordx4 v[28:31], v11, s[64:67], s77 offen offset:2304 sc1
    v_mfma_f32_16x16x32_bf16 v[68:71], v[32:35], v[148:151], v[68:71]
    v_mfma_f32_16x16x32_bf16 v[80:83], v[32:35], v[152:155], v[80:83]
    v_mfma_f32_16x16x32_bf16 v[84:87], v[32:35], v[156:159], v[84:87]
    s_waitcnt vmcnt(10)
    v_mfma_f32_16x16x32_bf16 v[96:99], v[36:39], v[144:147], v[96:99]
    s_add_u32 s77, s73, 8192
    buffer_load_dwordx4 v[32:35], v10, s[64:67], s77 offen offset:0 sc1
    v_mfma_f32_16x16x32_bf16 v[100:103], v[36:39], v[148:151], v[100:103]
    v_mfma_f32_16x16x32_bf16 v[112:115], v[36:39], v[152:155], v[112:115]
    v_mfma_f32_16x16x32_bf16 v[116:119], v[36:39], v[156:159], v[116:119]
    s_waitcnt vmcnt(10)
    v_mfma_f32_16x16x32_bf16 v[72:75], v[40:43], v[144:147], v[72:75]
    buffer_load_dwordx4 v[36:39], v11, s[64:67], s77 offen offset:0 sc1
    v_mfma_f32_16x16x32_bf16 v[76:79], v[40:43], v[148:151], v[76:79]
    v_mfma_f32_16x16x32_bf16 v[88:91], v[40:43], v[152:155], v[88:91]
    v_mfma_f32_16x16x32_bf16 v[92:95], v[40:43], v[156:159], v[92:95]
    s_waitcnt vmcnt(10)
    v_mfma_f32_16x16x32_bf16 v[104:107], v[44:47], v[144:147], v[104:107]
    buffer_load_dwordx4 v[40:43], v10, s[64:67], s77 offen offset:256 sc1
    v_mfma_f32_16x16x32_bf16 v[108:111], v[44:47], v[148:151], v[108:111]
    v_mfma_f32_16x16x32_bf16 v[120:123], v[44:47], v[152:155], v[120:123]
    v_mfma_f32_16x16x32_bf16 v[124:127], v[44:47], v[156:159], v[124:127]
    s_waitcnt vmcnt(10)
    v_mfma_f32_16x16x32_bf16 v[64:67], v[48:51], v[160:163], v[64:67]
    buffer_load_dwordx4 v[44:47], v11, s[64:67], s77 offen offset:256 sc1
    v_mfma_f32_16x16x32_bf16 v[68:71], v[48:51], v[164:167], v[68:71]
    v_mfma_f32_16x16x32_bf16 v[80:83], v[48:51], v[168:171], v[80:83]
    v_mfma_f32_16x16x32_bf16 v[84:87], v[48:51], v[172:175], v[84:87]
    s_waitcnt vmcnt(10)
    v_mfma_f32_16x16x32_bf16 v[96:99], v[52:55], v[160:163], v[96:99]
    buffer_load_dwordx4 v[48:51], v10, s[64:67], s77 offen offset:2048 sc1
    v_mfma_f32_16x16x32_bf16 v[100:103], v[52:55], v[164:167], v[100:103]
    v_mfma_f32_16x16x32_bf16 v[112:115], v[52:55], v[168:171], v[112:115]
    v_mfma_f32_16x16x32_bf16 v[116:119], v[52:55], v[172:175], v[116:119]
    s_waitcnt vmcnt(10)
    v_mfma_f32_16x16x32_bf16 v[72:75], v[56:59], v[160:163], v[72:75]
    buffer_load_dwordx4 v[52:55], v11, s[64:67], s77 offen offset:2048 sc1
    v_mfma_f32_16x16x32_bf16 v[76:79], v[56:59], v[164:167], v[76:79]
    v_mfma_f32_16x16x32_bf16 v[88:91], v[56:59], v[168:171], v[88:91]
    v_mfma_f32_16x16x32_bf16 v[92:95], v[56:59], v[172:175], v[92:95]
    s_waitcnt vmcnt(10)
    v_mfma_f32_16x16x32_bf16 v[104:107], v[60:63], v[160:163], v[104:107]
    buffer_load_dwordx4 v[56:59], v10, s[64:67], s77 offen offset:2304 sc1
    v_mfma_f32_16x16x32_bf16 v[108:111], v[60:63], v[164:167], v[108:111]
    v_mfma_f32_16x16x32_bf16 v[120:123], v[60:63], v[168:171], v[120:123]
    v_mfma_f32_16x16x32_bf16 v[124:127], v[60:63], v[172:175], v[124:127]
    s_waitcnt vmcnt(10)
    v_mfma_f32_16x16x32_bf16 v[64:67], v[16:19], v[176:179], v[64:67]
    buffer_load_dwordx4 v[60:63], v11, s[64:67], s77 offen offset:2304 sc1
    v_mfma_f32_16x16x32_bf16 v[68:71], v[16:19], v[180:183], v[68:71]
    v_mfma_f32_16x16x32_bf16 v[80:83], v[16:19], v[184:187], v[80:83]
    v_mfma_f32_16x16x32_bf16 v[84:87], v[16:19], v[188:191], v[84:87]
    s_waitcnt vmcnt(10)
    v_mfma_f32_16x16x32_bf16 v[96:99], v[20:23], v[176:179], v[96:99]
    s_add_u32 s77, s73, 12288
    buffer_load_dwordx4 v[16:19], v10, s[64:67], s77 offen offset:0 sc1
    v_mfma_f32_16x16x32_bf16 v[100:103], v[20:23], v[180:183], v[100:103]
    v_mfma_f32_16x16x32_bf16 v[112:115], v[20:23], v[184:187], v[112:115]
    v_mfma_f32_16x16x32_bf16 v[116:119], v[20:23], v[188:191], v[116:119]
    s_waitcnt vmcnt(10)
    v_mfma_f32_16x16x32_bf16 v[72:75], v[24:27], v[176:179], v[72:75]
    buffer_load_dwordx4 v[20:23], v11, s[64:67], s77 offen offset:0 sc1
    v_mfma_f32_16x16x32_bf16 v[76:79], v[24:27], v[180:183], v[76:79]
    v_mfma_f32_16x16x32_bf16 v[88:91], v[24:27], v[184:187], v[88:91]
    v_mfma_f32_16x16x32_bf16 v[92:95], v[24:27], v[188:191], v[92:95]
    s_waitcnt vmcnt(10)
    v_mfma_f32_16x16x32_bf16 v[104:107], v[28:31], v[176:179], v[104:107]
    buffer_load_dwordx4 v[24:27], v10, s[64:67], s77 offen offset:256 sc1
    v_mfma_f32_16x16x32_bf16 v[108:111], v[28:31], v[180:183], v[108:111]
    v_mfma_f32_16x16x32_bf16 v[120:123], v[28:31], v[184:187], v[120:123]
    v_mfma_f32_16x16x32_bf16 v[124:127], v[28:31], v[188:191], v[124:127]
    s_waitcnt vmcnt(10)
    v_mfma_f32_16x16x32_bf16 v[64:67], v[32:35], v[192:195], v[64:67]
    buffer_load_dwordx4 v[28:31], v11, s[64:67], s77 offen offset:256 sc1
    v_mfma_f32_16x16x32_bf16 v[68:71], v[32:35], v[196:199], v[68:71]
    v_mfma_f32_16x16x32_bf16 v[80:83], v[32:35], v[200:203], v[80:83]
    v_mfma_f32_16x16x32_bf16 v[84:87], v[32:35], v[204:207], v[84:87]
    s_waitcnt vmcnt(10)
    v_mfma_f32_16x16x32_bf16 v[96:99], v[36:39], v[192:195], v[96:99]
    buffer_load_dwordx4 v[32:35], v10, s[64:67], s77 offen offset:2048 sc1
    v_mfma_f32_16x16x32_bf16 v[100:103], v[36:39], v[196:199], v[100:103]
    v_mfma_f32_16x16x32_bf16 v[112:115], v[36:39], v[200:203], v[112:115]
    v_mfma_f32_16x16x32_bf16 v[116:119], v[36:39], v[204:207], v[116:119]
    s_waitcnt vmcnt(10)
    v_mfma_f32_16x16x32_bf16 v[72:75], v[40:43], v[192:195], v[72:75]
    buffer_load_dwordx4 v[36:39], v11, s[64:67], s77 offen offset:2048 sc1
    v_mfma_f32_16x16x32_bf16 v[76:79], v[40:43], v[196:199], v[76:79]
    v_mfma_f32_16x16x32_bf16 v[88:91], v[40:43], v[200:203], v[88:91]
    v_mfma_f32_16x16x32_bf16 v[92:95], v[40:43], v[204:207], v[92:95]
    s_waitcnt vmcnt(10)
    v_mfma_f32_16x16x32_bf16 v[104:107], v[44:47], v[192:195], v[104:107]
    buffer_load_dwordx4 v[40:43], v10, s[64:67], s77 offen offset:2304 sc1
    v_mfma_f32_16x16x32_bf16 v[108:111], v[44:47], v[196:199], v[108:111]
    v_mfma_f32_16x16x32_bf16 v[120:123], v[44:47], v[200:203], v[120:123]
    v_mfma_f32_16x16x32_bf16 v[124:127], v[44:47], v[204:207], v[124:127]
    s_waitcnt vmcnt(10)
    v_mfma_f32_16x16x32_bf16 v[64:67], v[48:51], v[208:211], v[64:67]
    buffer_load_dwordx4 v[44:47], v11, s[64:67], s77 offen offset:2304 sc1
    v_mfma_f32_16x16x32_bf16 v[68:71], v[48:51], v[212:215], v[68:71]
    v_mfma_f32_16x16x32_bf16 v[80:83], v[48:51], v[216:219], v[80:83]
    v_mfma_f32_16x16x32_bf16 v[84:87], v[48:51], v[220:223], v[84:87]
    s_waitcnt vmcnt(10)
    v_mfma_f32_16x16x32_bf16 v[96:99], v[52:55], v[208:211], v[96:99]
    v_mfma_f32_16x16x32_bf16 v[100:103], v[52:55], v[212:215], v[100:103]
    v_mfma_f32_16x16x32_bf16 v[112:115], v[52:55], v[216:219], v[112:115]
    v_mfma_f32_16x16x32_bf16 v[116:119], v[52:55], v[220:223], v[116:119]
    s_waitcnt vmcnt(9)
    v_mfma_f32_16x16x32_bf16 v[72:75], v[56:59], v[208:211], v[72:75]
    v_mfma_f32_16x16x32_bf16 v[76:79], v[56:59], v[212:215], v[76:79]
    v_mfma_f32_16x16x32_bf16 v[88:91], v[56:59], v[216:219], v[88:91]
    v_mfma_f32_16x16x32_bf16 v[92:95], v[56:59], v[220:223], v[92:95]
    s_waitcnt vmcnt(8)
    v_mfma_f32_16x16x32_bf16 v[104:107], v[60:63], v[208:211], v[104:107]
    v_mfma_f32_16x16x32_bf16 v[108:111], v[60:63], v[212:215], v[108:111]
    v_mfma_f32_16x16x32_bf16 v[120:123], v[60:63], v[216:219], v[120:123]
    v_mfma_f32_16x16x32_bf16 v[124:127], v[60:63], v[220:223], v[124:127]
    s_waitcnt vmcnt(7)
    v_mfma_f32_16x16x32_bf16 v[64:67], v[16:19], v[224:227], v[64:67]
    v_mfma_f32_16x16x32_bf16 v[68:71], v[16:19], v[228:231], v[68:71]
    v_mfma_f32_16x16x32_bf16 v[80:83], v[16:19], v[232:235], v[80:83]
    v_mfma_f32_16x16x32_bf16 v[84:87], v[16:19], v[236:239], v[84:87]
    s_waitcnt vmcnt(6)
    v_mfma_f32_16x16x32_bf16 v[96:99], v[20:23], v[224:227], v[96:99]
    v_mfma_f32_16x16x32_bf16 v[100:103], v[20:23], v[228:231], v[100:103]
    v_mfma_f32_16x16x32_bf16 v[112:115], v[20:23], v[232:235], v[112:115]
    v_mfma_f32_16x16x32_bf16 v[116:119], v[20:23], v[236:239], v[116:119]
    s_waitcnt vmcnt(5)
    v_mfma_f32_16x16x32_bf16 v[72:75], v[24:27], v[224:227], v[72:75]
    v_mfma_f32_16x16x32_bf16 v[76:79], v[24:27], v[228:231], v[76:79]
    v_mfma_f32_16x16x32_bf16 v[88:91], v[24:27], v[232:235], v[88:91]
    v_mfma_f32_16x16x32_bf16 v[92:95], v[24:27], v[236:239], v[92:95]
    s_waitcnt vmcnt(4)
    v_mfma_f32_16x16x32_bf16 v[104:107], v[28:31], v[224:227], v[104:107]
    v_mfma_f32_16x16x32_bf16 v[108:111], v[28:31], v[228:231], v[108:111]
    v_mfma_f32_16x16x32_bf16 v[120:123], v[28:31], v[232:235], v[120:123]
    v_mfma_f32_16x16x32_bf16 v[124:127], v[28:31], v[236:239], v[124:127]
    s_waitcnt vmcnt(3)
    v_mfma_f32_16x16x32_bf16 v[64:67], v[32:35], v[240:243], v[64:67]
    v_mfma_f32_16x16x32_bf16 v[68:71], v[32:35], v[244:247], v[68:71]
    v_mfma_f32_16x16x32_bf16 v[80:83], v[32:35], v[248:251], v[80:83]
    v_mfma_f32_16x16x32_bf16 v[84:87], v[32:35], v[252:255], v[84:87]
    s_waitcnt vmcnt(2)
    v_mfma_f32_16x16x32_bf16 v[96:99], v[36:39], v[240:243], v[96:99]
    v_mfma_f32_16x16x32_bf16 v[100:103], v[36:39], v[244:247], v[100:103]
    v_mfma_f32_16x16x32_bf16 v[112:115], v[36:39], v[248:251], v[112:115]
    v_mfma_f32_16x16x32_bf16 v[116:119], v[36:39], v[252:255], v[116:119]
    s_waitcnt vmcnt(1)
    v_mfma_f32_16x16x32_bf16 v[72:75], v[40:43], v[240:243], v[72:75]
    v_mfma_f32_16x16x32_bf16 v[76:79], v[40:43], v[244:247], v[76:79]
    v_mfma_f32_16x16x32_bf16 v[88:91], v[40:43], v[248:251], v[88:91]
    v_mfma_f32_16x16x32_bf16 v[92:95], v[40:43], v[252:255], v[92:95]
    s_waitcnt vmcnt(0)
    v_mfma_f32_16x16x32_bf16 v[104:107], v[44:47], v[240:243], v[104:107]
    v_mfma_f32_16x16x32_bf16 v[108:111], v[44:47], v[244:247], v[108:111]
    v_mfma_f32_16x16x32_bf16 v[120:123], v[44:47], v[248:251], v[120:123]
    v_mfma_f32_16x16x32_bf16 v[124:127], v[44:47], v[252:255], v[124:127]
    s_nop 7
    s_setprio 0
    v_lshl_add_u32 v5, v0, 4, s13
    ds_write_b128 v5, v[80:83] offset:0
    ds_write_b128 v5, v[84:87] offset:1024
    ds_write_b128 v5, v[88:91] offset:2048
    ds_write_b128 v5, v[92:95] offset:3072
    ds_write_b128 v5, v[96:99] offset:4096
    ds_write_b128 v5, v[100:103] offset:5120
    ds_write_b128 v5, v[104:107] offset:6144
    ds_write_b128 v5, v[108:111] offset:7168
    ds_write_b128 v5, v[112:115] offset:8192
    ds_write_b128 v5, v[116:119] offset:9216
    ds_write_b128 v5, v[120:123] offset:10240
    ds_write_b128 v5, v[124:127] offset:11264
    ds_add_u32 v14, v15 offset:32
    s_mov_b32 s76, 0x800000
SPIN_51:
    ds_read_b32 v2, v14 offset:32
    s_waitcnt lgkmcnt(0)
    v_readfirstlane_b32 s80, v2
    s_sub_u32 s76, s76, 1
    s_cbranch_scc1 SPR_53
    s_cmp_eq_u32 s80, 4
    s_cbranch_scc1 SPR_53
    s_sleep 1
    s_branch SPIN_51
SPR_53:
SPD_52:
    s_xor_b32 s77, s4, 1
    s_mul_i32 s77, s77, 12288
    s_add_u32 s77, s77, 0
    v_lshl_add_u32 v2, v0, 4, s77
    ds_read_b128 v[16:19], v2 offset:0
    ds_read_b128 v[20:23], v2 offset:1024
    ds_read_b128 v[24:27], v2 offset:2048
    ds_read_b128 v[28:31], v2 offset:3072
    s_xor_b32 s77, s4, 2
    s_mul_i32 s77, s77, 12288
    s_add_u32 s77, s77, 4096
    v_lshl_add_u32 v2, v0, 4, s77
    ds_read_b128 v[32:35], v2 offset:0
    ds_read_b128 v[36:39], v2 offset:1024
    ds_read_b128 v[40:43], v2 offset:2048
    ds_read_b128 v[44:47], v2 offset:3072
    s_xor_b32 s77, s4, 3
    s_mul_i32 s77, s77, 12288
    s_add_u32 s77, s77, 8192
    v_lshl_add_u32 v2, v0, 4, s77
    ds_read_b128 v[48:51], v2 offset:0
    ds_read_b128 v[52:55], v2 offset:1024
    ds_read_b128 v[56:59], v2 offset:2048
    ds_read_b128 v[60:63], v2 offset:3072
    s_xor_b32 s77, s4, 1
    s_mul_i32 s77, s77, 12288
    v_lshl_add_u32 v5, v0, 4, s77
    s_waitcnt lgkmcnt(8)
    v_add_f32 v64, v64, v16
    v_add_f32 v65, v65, v17
    v_add_f32 v66, v66, v18
    v_add_f32 v67, v67, v19
    v_add_f32 v68, v68, v20
    v_add_f32 v69, v69, v21
    v_add_f32 v70, v70, v22
    v_add_f32 v71, v71, v23
    v_add_f32 v72, v72, v24
    v_add_f32 v73, v73, v25
    v_add_f32 v74, v74, v26
    v_add_f32 v75, v75, v27
    v_add_f32 v76, v76, v28
    v_add_f32 v77, v77, v29
    v_add_f32 v78, v78, v30
    v_add_f32 v79, v79, v31
    s_waitcnt lgkmcnt(4)
    v_add_f32 v64, v64, v32
    v_add_f32 v65, v65, v33
    v_add_f32 v66, v66, v34
    v_add_f32 v67, v67, v35
    v_add_f32 v68, v68, v36
    v_add_f32 v69, v69, v37
    v_add_f32 v70, v70, v38
    v_add_f32 v71, v71, v39
    v_add_f32 v72, v72, v40
    v_add_f32 v73, v73, v41
    v_add_f32 v74, v74, v42
    v_add_f32 v75, v75, v43
    v_add_f32 v76, v76, v44
    v_add_f32 v77, v77, v45
    v_add_f32 v78, v78, v46
    v_add_f32 v79, v79, v47
    s_waitcnt lgkmcnt(0)
    v_add_f32 v64, v64, v48
    v_add_f32 v65, v65, v49
    v_add_f32 v66, v66, v50
    v_add_f32 v67, v67, v51
    v_add_f32 v68, v68, v52
    v_add_f32 v69, v69, v53
    v_add_f32 v70, v70, v54
    v_add_f32 v71, v71, v55
    v_add_f32 v72, v72, v56
    v_add_f32 v73, v73, v57
    v_add_f32 v74, v74, v58
    v_add_f32 v75, v75, v59
    v_add_f32 v76, v76, v60
    v_add_f32 v77, v77, v61
    v_add_f32 v78, v78, v62
    v_add_f32 v79, v79, v63
    ds_write_b128 v5, v[64:67] offset:0
    ds_write_b128 v5, v[68:71] offset:1024
    ds_write_b128 v5, v[72:75] offset:2048
    ds_write_b128 v5, v[76:79] offset:3072
    ds_add_u32 v14, v15 offset:36
    s_setprio 0
    s_mov_b32 s68, s42
    s_mov_b32 s69, s43
    s_mov_b32 s70, 0x400000
    s_mov_b32 s71, 0x20000
    v_lshlrev_b32 v9, 4, v0
    v_and_b32 v8, 31, v0
    v_lshlrev_b32 v8, 2, v8
    v_and_b32 v4, 32, v0
    v_lshl_add_u32 v8, v4, 10, v8
    v_and_b32 v6, 15, v0
    v_lshlrev_b32 v6, 4, v6
    v_lshl_add_u32 v6, v4, 3, v6
    v_and_b32 v4, 16, v0
    v_lshl_add_u32 v6, v4, 6, v6
    s_and_b32 s77, s4, 2
    s_add_u32 s77, s77, s4
    s_lshl_b32 s77, s77, 9
    v_add_u32 v6, s77, v6
    v_add_u32 v4, 49152, v6
    v_add_u32 v5, 122880, v6
    s_lshl_b32 s11, s7, 17
    s_lshl_b32 s77, s4, 13
    s_add_u32 s11, s11, s77
    s_lshl_b32 s77, s8, 8
    s_add_u32 s11, s11, s77
    s_mov_b32 s76, 0x800000
SPIN_54:
    ds_read_b32 v2, v14 offset:40
    s_waitcnt lgkmcnt(0)
    v_readfirstlane_b32 s80, v2
    s_sub_u32 s76, s76, 1
    s_cbranch_scc1 SPR_56
    s_cmp_eq_u32 s80, 4
    s_cbranch_scc1 SPR_56
    s_sleep 1
    s_branch SPIN_54
SPR_56:
SPD_55:
    ds_read_b128 v[64:67], v6 offset:12288
    ds_read_b128 v[68:71], v6 offset:0
    ds_read_b128 v[72:75], v6 offset:36864
    ds_read_b128 v[16:19], v6 offset:4096
    ds_read_b128 v[20:23], v6 offset:16384
    ds_read_b128 v[24:27], v6 offset:28672
    ds_read_b128 v[28:31], v6 offset:40960
    ds_read_b128 v[32:35], v6 offset:8192
    ds_read_b128 v[36:39], v6 offset:20480
    ds_read_b128 v[40:43], v6 offset:32768
    ds_read_b128 v[44:47], v6 offset:45056
    s_add_u32 s77, s11, 0
    s_add_u32 s78, s77, 4096
    s_waitcnt lgkmcnt(6)
    v_add_f32 v64, v64, v16
    v_add_f32 v65, v65, v17
    v_add_f32 v66, v66, v18
    v_add_f32 v67, v67, v19
    v_add_f32 v64, v64, v20
    v_add_f32 v65, v65, v21
    v_add_f32 v66, v66, v22
    v_add_f32 v67, v67, v23
    s_waitcnt lgkmcnt(4)
    v_add_f32 v24, v24, v28
    v_add_f32 v25, v25, v29
    v_add_f32 v26, v26, v30
    v_add_f32 v27, v27, v31
    v_add_f32 v64, v64, v24
    buffer_store_dword v64, v8, s[68:71], s77 offen offset:0 sc1
    v_add_f32 v65, v65, v25
    buffer_store_dword v65, v8, s[68:71], s77 offen offset:2048 sc1
    v_add_f32 v66, v66, v26
    buffer_store_dword v66, v8, s[68:71], s78 offen offset:0 sc1
    v_add_f32 v67, v67, v27
    buffer_store_dword v67, v8, s[68:71], s78 offen offset:2048 sc1
    s_add_u32 s77, s11, 128
    s_add_u32 s78, s77, 4096
    s_waitcnt lgkmcnt(2)
    v_add_f32 v68, v68, v32
    v_add_f32 v69, v69, v33
    v_add_f32 v70, v70, v34
    v_add_f32 v71, v71, v35
    v_add_f32 v68, v68, v36
    v_add_f32 v69, v69, v37
    v_add_f32 v70, v70, v38
    v_add_f32 v71, v71, v39
    s_waitcnt lgkmcnt(0)
    v_add_f32 v40, v40, v44
    v_add_f32 v41, v41, v45
    v_add_f32 v42, v42, v46
    v_add_f32 v43, v43, v47
    v_add_f32 v68, v68, v40
    buffer_store_dword v68, v8, s[68:71], s77 offen offset:0 sc1
    v_add_f32 v69, v69, v41
    buffer_store_dword v69, v8, s[68:71], s77 offen offset:2048 sc1
    v_add_f32 v70, v70, v42
    buffer_store_dword v70, v8, s[68:71], s78 offen offset:0 sc1
    v_add_f32 v71, v71, v43
    buffer_store_dword v71, v8, s[68:71], s78 offen offset:2048 sc1
    s_add_u32 s77, s11, 65536
    s_add_u32 s78, s77, 4096
    s_setprio 1
    s_barrier
    ds_read_b128 v[16:19], v4 offset:0
    ds_read_b128 v[20:23], v4 offset:24576
    ds_read_b128 v[24:27], v4 offset:49152
    ds_read_b128 v[28:31], v5 offset:0
    s_waitcnt lgkmcnt(3)
    v_pk_add_f32 v[72:73], v[72:73], v[16:17]
    v_pk_add_f32 v[74:75], v[74:75], v[18:19]
    s_waitcnt lgkmcnt(2)
    v_pk_add_f32 v[72:73], v[72:73], v[20:21]
    v_pk_add_f32 v[74:75], v[74:75], v[22:23]
    s_waitcnt lgkmcnt(0)
    v_pk_add_f32 v[24:25], v[24:25], v[28:29]
    v_pk_add_f32 v[26:27], v[26:27], v[30:31]
    v_pk_add_f32 v[72:73], v[72:73], v[24:25]
    v_pk_add_f32 v[74:75], v[74:75], v[26:27]
    buffer_store_dword v72, v8, s[68:71], s77 offen offset:0 sc1
    buffer_store_dword v73, v8, s[68:71], s77 offen offset:2048 sc1
    buffer_store_dword v74, v8, s[68:71], s78 offen offset:0 sc1
    buffer_store_dword v75, v8, s[68:71], s78 offen offset:2048 sc1
L_END:
    s_endpgm
L_CODE_END:
.section .rodata,"a"
.p2align 6
.amdhsa_kernel parallel_sum__ssm_conv_s5__dense_activation_silu__prompt_kernel
  .amdhsa_next_free_vgpr 256
  .amdhsa_next_free_sgpr 102
  .amdhsa_accum_offset 256
  .amdhsa_group_segment_fixed_size 0
  .amdhsa_kernarg_size 120
  .amdhsa_user_sgpr_count 2
  .amdhsa_user_sgpr_kernarg_segment_ptr 1
  .amdhsa_system_sgpr_workgroup_id_x 1
.end_amdhsa_kernel
```
